```python
import torch

def _softmax(x, axis=-1):
    return torch.softmax(x, dim=axis)
def _gelu(x):
    return torch.nn.functional.gelu(x, approximate="tanh")
def _silu(x):
    return torch.nn.functional.silu(x)
def _sigmoid(x):
    return torch.sigmoid(x)
def _layernorm(x, axis=-1, eps=1e-5):
    m = x.mean(dim=axis, keepdim=True)
    v = x.var(dim=axis, keepdim=True, unbiased=False)
    return (x - m) / torch.sqrt(v + eps)
def _scatter_add(tgt, idx, src, axis=0):
    return tgt.clone().index_add_(axis, idx, src)
def _segment_sum(src, seg, n):
    out = torch.zeros((n,) + src.shape[1:], dtype=src.dtype)
    return out.index_add_(0, seg, src)
def _pad(x, pw):
    flat = tuple(v for pair in reversed(pw) for v in pair)
    return torch.nn.functional.pad(x, flat)

kernel_name = 'recurrent_scan__sliding_block_cached__glu_gated_reglu__decode'

def setup_inputs():

    _w = (lambda a: (lambda t: t.to(torch.bfloat16) if t.is_floating_point() else t)(torch.as_tensor(a)))
    def _A_setup():
        B, Sq, D = 4, 1, 448
        Hq, Hkv, Sk, Dh = 16, 8, 8192, 256
        assert Hq % Hkv == 0, (Hq, Hkv)
        return {
            "x": _w((lambda *s: torch.randn(*s, dtype=torch.bfloat16) * 0.05)(B, Sq, D)),
            "k_cache": _w((lambda *s: torch.randn(*s, dtype=torch.bfloat16) * 3.2)(B, Hkv, Sk, Dh)),
            "v_cache": _w((lambda *s: torch.randn(*s, dtype=torch.bfloat16) * 3.2)(B, Hkv, Sk, Dh)),
            "wq": _w((lambda *s: torch.randn(*s, dtype=torch.bfloat16) * 3.2)(D, Hq * Dh) * (D ** -0.5)),
            "wo": _w((lambda *s: torch.randn(*s, dtype=torch.bfloat16) * 3.2)(Hq * Dh, D) * ((Hq * Dh) ** -0.5)),
        }
    _A_in = _A_setup()

    def _B_setup():
        B, S, D, F = 4, 1, 448, 1792
        return {
            "x": _w((lambda *s: torch.randn(*s, dtype=torch.bfloat16) * 0.05)(B, S, D)),
            "W_gate": _w((lambda *s: torch.randn(*s, dtype=torch.bfloat16) * 0.4)(D, F) * (2.0 / D) ** 0.5),
            "W_up": _w((lambda *s: torch.randn(*s, dtype=torch.bfloat16) * 0.4)(D, F) * (2.0 / D) ** 0.5),
            "W_down": _w((lambda *s: torch.randn(*s, dtype=torch.bfloat16) * 0.4)(F, D) * (1.0 / F) ** 0.5),
        }
    _B_in = _B_setup()

    return {
        "A_x": _A_in["x"],
        "A_k_cache": _A_in["k_cache"],
        "A_v_cache": _A_in["v_cache"],
        "A_wq": _A_in["wq"],
        "A_wo": _A_in["wo"],
        "B_x": _B_in["x"],
        "B_W_gate": _B_in["W_gate"],
        "B_W_up": _B_in["W_up"],
        "B_W_down": _B_in["W_down"],
    }

def reference(A_x, A_k_cache, A_v_cache, A_wq, A_wo, B_x, B_W_gate, B_W_up, B_W_down):
    def _A_ref(x, k_cache, v_cache, wq, wo):
        B, Sq, D = x.shape
        Hq, Dh = 16, 256
        Hkv, Sk = k_cache.shape[1], k_cache.shape[2]
        W = min(4096, max(256, Sk // 4))
        rep = Hq // Hkv
        q = (lambda x, *d: x.permute(*d))((x @ wq).reshape(B, Sq, Hq, Dh), 0, 2, 1, 3)
        k = (lambda x, n, axis: torch.repeat_interleave(x, n, dim=axis))(k_cache[:, :, Sk - W:, :], rep, axis=1)
        v = (lambda x, n, axis: torch.repeat_interleave(x, n, dim=axis))(v_cache[:, :, Sk - W:, :], rep, axis=1)
        scores = torch.einsum("bhqd,bhkd->bhqk", q, k) * (Dh ** -0.5)
        p = _softmax(scores, axis=-1)
        o = torch.einsum("bhqk,bhkd->bhqd", p, v)
        return (lambda x, *d: x.permute(*d))(o, 0, 2, 1, 3).reshape(B, Sq, Hq * Dh) @ wo

    def _B_ref(x, W_gate, W_up, W_down):
        gate = torch.einsum("bsd,df->bsf", x, W_gate)
        up = torch.einsum("bsd,df->bsf", x, W_up)
        gate = gate * (lambda x, dt: x.to(dt))(gate > 0, gate.dtype)
        h = gate * up
        return torch.einsum("bsf,fd->bsd", h, W_down)

    x = A_x
    xn = _layernorm(x, axis=-1)
    s = _A_ref(xn, A_k_cache, A_v_cache, A_wq, A_wo)
    g = _silu(_B_ref(xn, B_W_gate, B_W_up, B_W_down))
    return x + s * g
```

```asm
; @launch grid=(256,1,1) block=(448,1,1) lds=163840
.amdgcn_target "amdgcn-amd-amdhsa--gfx950"
.text
.globl recurrent_scan__sliding_block_cached__glu_gated_reglu__decode_kernel
.p2align 8
.type recurrent_scan__sliding_block_cached__glu_gated_reglu__decode_kernel,@function
recurrent_scan__sliding_block_cached__glu_gated_reglu__decode_kernel:
L_START:
    s_cmp_ge_u32 s2, 256
    s_cbranch_scc1 L_END
    s_load_dwordx16 s[8:23], s[0:1], 0
    s_load_dwordx8 s[24:31], s[0:1], 64
    v_lshrrev_b32 v1, 6, v0
    s_and_b32 s4, s2, 7
    v_readfirstlane_b32 s3, v1
    s_lshr_b32 s5, s2, 3
    s_lshr_b32 s6, s5, 3
    s_and_b32 s7, s5, 7
    v_and_b32 v1, 63, v0
    s_cmp_eq_u32 s3, 5
    s_cbranch_scc1 L_F
    s_cmp_eq_u32 s3, 6
    s_cbranch_scc1 L_G
    s_cmp_lg_u32 s3, 0
    s_cbranch_scc1 L_C
    s_setprio 1
    v_lshrrev_b32 v18, 3, v1
    v_and_b32 v19, 7, v1
    v_and_b32 v20, 6, v18
    v_xor_b32 v20, v20, v19
    v_lshlrev_b32 v20, 4, v20
    v_lshl_add_u32 v11, v18, 13, v20
    v_mul_u32_u24 v12, 3584, v18
    v_add_u32 v12, v12, v20
    v_mul_u32_u24 v13, 896, v18
    v_add_u32 v13, v13, v20
    s_lshr_b32 s53, s5, 3
    s_mul_i32 s51, s53, 917504
    s_lshl_b32 s53, s4, 10
    s_add_u32 s51, s51, s53
    s_and_b32 s53, s5, 7
    s_lshl_b32 s53, s53, 7
    s_add_u32 s51, s51, s53
    v_lshrrev_b32 v18, 5, v1
    v_and_b32 v22, 31, v1
    v_add_u32 v20, 0, v18
    v_xor_b32 v20, v20, v22
    v_lshlrev_b32 v20, 4, v20
    v_lshl_add_u32 v2, v18, 9, v20
    v_add_u32 v20, 2, v18
    v_xor_b32 v20, v20, v22
    v_lshlrev_b32 v20, 4, v20
    v_lshl_add_u32 v3, v18, 9, v20
    v_add_u32 v20, 4, v18
    v_xor_b32 v20, v20, v22
    v_lshlrev_b32 v20, 4, v20
    v_lshl_add_u32 v4, v18, 9, v20
    v_add_u32 v20, 6, v18
    v_xor_b32 v20, v20, v22
    v_lshlrev_b32 v20, 4, v20
    v_lshl_add_u32 v5, v18, 9, v20
    v_add_u32 v20, 8, v18
    v_xor_b32 v20, v20, v22
    v_lshlrev_b32 v20, 4, v20
    v_lshl_add_u32 v6, v18, 9, v20
    v_add_u32 v20, 10, v18
    v_xor_b32 v20, v20, v22
    v_lshlrev_b32 v20, 4, v20
    v_lshl_add_u32 v7, v18, 9, v20
    v_add_u32 v20, 12, v18
    v_xor_b32 v20, v20, v22
    v_lshlrev_b32 v20, 4, v20
    v_lshl_add_u32 v8, v18, 9, v20
    v_add_u32 v20, 14, v18
    v_xor_b32 v20, v20, v22
    v_lshlrev_b32 v20, 4, v20
    v_lshl_add_u32 v9, v18, 9, v20
    s_lshl_b32 s48, s6, 3
    s_add_u32 s48, s48, s4
    s_lshl_b32 s48, s48, 22
    s_add_u32 s48, s48, 0x300000
    s_lshl_b32 s49, s7, 17
    s_add_u32 s49, s49, s48
    s_mul_i32 s59, s5, 5
    s_mul_i32 s61, s4, 3
    s_add_u32 s59, s59, s61
    s_and_b32 s59, s59, 15
    v_mov_b32 v15, 163712
    s_waitcnt lgkmcnt(0)
    s_mov_b32 s40, s14
    s_mov_b32 s41, s15
    s_mov_b32 s42, 3670016
    s_mov_b32 s43, 0x20000
    s_mov_b32 s32, s10
    s_mov_b32 s33, s11
    s_mov_b32 s34, 134217728
    s_mov_b32 s35, 0x20000
    s_mov_b32 m0, 98304
    s_add_u32 s60, s51, 0
    buffer_load_dwordx4 v11, s[40:43], s60 offen nt lds
    s_mov_b32 m0, 99328
    s_add_u32 s60, s51, 65536
    buffer_load_dwordx4 v11, s[40:43], s60 offen nt lds
    s_mov_b32 m0, 100352
    s_add_u32 s60, s51, 131072
    buffer_load_dwordx4 v11, s[40:43], s60 offen nt lds
    s_mov_b32 m0, 101376
    s_add_u32 s60, s51, 196608
    buffer_load_dwordx4 v11, s[40:43], s60 offen nt lds
    s_mov_b32 m0, 102400
    s_add_u32 s60, s51, 262144
    buffer_load_dwordx4 v11, s[40:43], s60 offen nt lds
    s_mov_b32 m0, 103424
    s_add_u32 s60, s51, 327680
    buffer_load_dwordx4 v11, s[40:43], s60 offen nt lds
    s_mov_b32 m0, 104448
    s_add_u32 s60, s51, 393216
    buffer_load_dwordx4 v11, s[40:43], s60 offen nt lds
    s_mov_b32 m0, 105472
    s_add_u32 s60, s51, 458752
    buffer_load_dwordx4 v11, s[40:43], s60 offen nt lds
    s_mov_b32 m0, 106496
    s_add_u32 s60, s51, 524288
    buffer_load_dwordx4 v11, s[40:43], s60 offen nt lds
    s_mov_b32 m0, 107520
    s_add_u32 s60, s51, 589824
    buffer_load_dwordx4 v11, s[40:43], s60 offen nt lds
    s_mov_b32 m0, 108544
    s_add_u32 s60, s51, 655360
    buffer_load_dwordx4 v11, s[40:43], s60 offen nt lds
    s_mov_b32 m0, 109568
    s_add_u32 s60, s51, 720896
    buffer_load_dwordx4 v11, s[40:43], s60 offen nt lds
    s_mov_b32 m0, 110592
    s_add_u32 s60, s51, 786432
    buffer_load_dwordx4 v11, s[40:43], s60 offen nt lds
    s_mov_b32 m0, 111616
    s_add_u32 s60, s51, 851968
    buffer_load_dwordx4 v11, s[40:43], s60 offen nt lds
    s_barrier
    s_add_u32 s61, s59, 0
    s_and_b32 s61, s61, 15
    s_lshl_b32 s61, s61, 13
    s_add_u32 s61, s61, s49
    s_mov_b32 m0, 0
    s_add_u32 s60, s61, 0
    buffer_load_dwordx4 v2, s[32:35], s60 offen offset:0 nt lds
    buffer_load_dwordx4 v3, s[32:35], s60 offen offset:1024 nt lds
    buffer_load_dwordx4 v4, s[32:35], s60 offen offset:2048 nt lds
    buffer_load_dwordx4 v5, s[32:35], s60 offen offset:3072 nt lds
    s_mov_b32 m0, 4096
    s_add_u32 s60, s61, 4096
    buffer_load_dwordx4 v6, s[32:35], s60 offen offset:0 nt lds
    buffer_load_dwordx4 v7, s[32:35], s60 offen offset:1024 nt lds
    buffer_load_dwordx4 v8, s[32:35], s60 offen offset:2048 nt lds
    buffer_load_dwordx4 v9, s[32:35], s60 offen offset:3072 nt lds
    s_mov_b32 s36, s12
    s_mov_b32 s37, s13
    s_mov_b32 s38, 134217728
    s_mov_b32 s39, 0x20000
    s_mov_b32 s44, s24
    s_mov_b32 s45, s25
    s_mov_b32 s46, 1605632
    s_mov_b32 s47, 0x20000
    s_mov_b32 s64, s16
    s_mov_b32 s65, s17
    s_mov_b32 s66, 3670016
    s_mov_b32 s67, 0x20000
    v_add_u32 v20, 0, v18
    v_lshlrev_b32 v20, 1, v20
    v_xor_b32 v20, v20, v22
    v_lshlrev_b32 v20, 4, v20
    v_lshl_add_u32 v24, v18, 9, v20
    v_add_u32 v20, 2, v18
    v_lshlrev_b32 v20, 1, v20
    v_xor_b32 v20, v20, v22
    v_lshlrev_b32 v20, 4, v20
    v_lshl_add_u32 v25, v18, 9, v20
    v_add_u32 v20, 4, v18
    v_lshlrev_b32 v20, 1, v20
    v_xor_b32 v20, v20, v22
    v_lshlrev_b32 v20, 4, v20
    v_lshl_add_u32 v26, v18, 9, v20
    v_add_u32 v20, 6, v18
    v_lshlrev_b32 v20, 1, v20
    v_xor_b32 v20, v20, v22
    v_lshlrev_b32 v20, 4, v20
    v_lshl_add_u32 v27, v18, 9, v20
    s_lshr_b32 s52, s5, 3
    s_bfe_u32 s53, s5, 0x10002
    s_and_b32 s54, s5, 3
    s_lshl_b32 s56, s52, 3
    s_add_u32 s55, s56, s4
    s_min_u32 s55, s55, 27
    s_cmp_eq_u32 s53, 0
    s_cselect_b32 s68, s20, s22
    s_cselect_b32 s69, s21, s23
    s_mov_b32 s70, 1605632
    s_mov_b32 s71, 0x20000
    s_mul_i32 s54, s54, 401408
    s_lshl_b32 s55, s55, 7
    s_add_u32 s54, s54, s55
    s_min_u32 s56, s5, 27
    s_mul_i32 s52, s56, 37
    s_lshr_b32 s52, s52, 8
    s_mul_i32 s53, s52, 7
    s_sub_u32 s53, s56, s53
    s_lshl_b32 s56, s52, 3
    s_add_u32 s55, s56, s4
    s_min_u32 s55, s55, 27
    s_mul_i32 s57, s55, 57344
    s_lshl_b32 s53, s53, 7
    s_add_u32 s57, s57, s53
    s_min_u32 s56, s5, 27
    s_mul_i32 s52, s56, 37
    s_lshr_b32 s52, s52, 8
    s_mul_i32 s53, s52, 7
    s_sub_u32 s53, s56, s53
    s_lshl_b32 s58, s4, 2
    s_add_u32 s58, s58, s52
    s_mul_i32 s58, s58, 114688
    s_lshl_b32 s53, s53, 7
    s_add_u32 s58, s58, s53
    s_add_u32 s61, s59, 1
    s_and_b32 s61, s61, 15
    s_lshl_b32 s61, s61, 13
    s_add_u32 s61, s61, s49
    s_mov_b32 m0, 8192
    s_add_u32 s60, s61, 0
    buffer_load_dwordx4 v2, s[32:35], s60 offen offset:0 nt lds
    buffer_load_dwordx4 v3, s[32:35], s60 offen offset:1024 nt lds
    buffer_load_dwordx4 v4, s[32:35], s60 offen offset:2048 nt lds
    s_waitcnt vmcnt(24)
    buffer_load_dwordx4 v5, s[32:35], s60 offen offset:3072 nt lds
    s_mov_b32 m0, 12288
    s_add_u32 s60, s61, 4096
    buffer_load_dwordx4 v6, s[32:35], s60 offen offset:0 nt lds
    buffer_load_dwordx4 v7, s[32:35], s60 offen offset:1024 nt lds
    buffer_load_dwordx4 v8, s[32:35], s60 offen offset:2048 nt lds
    buffer_load_dwordx4 v9, s[32:35], s60 offen offset:3072 nt lds
    s_waitcnt vmcnt(24)
    s_add_u32 s61, s59, 2
    s_and_b32 s61, s61, 15
    s_lshl_b32 s61, s61, 13
    s_add_u32 s61, s61, s49
    s_mov_b32 m0, 16384
    s_add_u32 s60, s61, 0
    buffer_load_dwordx4 v2, s[32:35], s60 offen offset:0 nt lds
    buffer_load_dwordx4 v3, s[32:35], s60 offen offset:1024 nt lds
    buffer_load_dwordx4 v4, s[32:35], s60 offen offset:2048 nt lds
    buffer_load_dwordx4 v5, s[32:35], s60 offen offset:3072 nt lds
    s_mov_b32 m0, 20480
    s_add_u32 s60, s61, 4096
    buffer_load_dwordx4 v6, s[32:35], s60 offen offset:0 nt lds
    buffer_load_dwordx4 v7, s[32:35], s60 offen offset:1024 nt lds
    buffer_load_dwordx4 v8, s[32:35], s60 offen offset:2048 nt lds
    buffer_load_dwordx4 v9, s[32:35], s60 offen offset:3072 nt lds
    s_waitcnt vmcnt(24)
    s_mov_b64 exec, 1
    v_mov_b32 v16, 1
    ds_write_b32 v15, v16 offset:4
    s_mov_b64 exec, -1
    s_add_u32 s61, s59, 3
    s_and_b32 s61, s61, 15
    s_lshl_b32 s61, s61, 13
    s_add_u32 s61, s61, s49
    s_mov_b32 m0, 24576
    s_add_u32 s60, s61, 0
    buffer_load_dwordx4 v2, s[32:35], s60 offen offset:0 nt lds
    buffer_load_dwordx4 v3, s[32:35], s60 offen offset:1024 nt lds
    buffer_load_dwordx4 v4, s[32:35], s60 offen offset:2048 nt lds
    buffer_load_dwordx4 v5, s[32:35], s60 offen offset:3072 nt lds
    s_mov_b32 m0, 28672
    s_add_u32 s60, s61, 4096
    buffer_load_dwordx4 v6, s[32:35], s60 offen offset:0 nt lds
    buffer_load_dwordx4 v7, s[32:35], s60 offen offset:1024 nt lds
    buffer_load_dwordx4 v8, s[32:35], s60 offen offset:2048 nt lds
    buffer_load_dwordx4 v9, s[32:35], s60 offen offset:3072 nt lds
    s_waitcnt vmcnt(24)
    s_mov_b64 exec, 1
    v_mov_b32 v16, 1
    ds_write_b32 v15, v16 offset:12
    s_mov_b64 exec, -1
    s_mov_b32 m0, 114688
    s_add_u32 s60, s54, 0
    buffer_load_dwordx4 v12, s[68:71], s60 offen nt lds
    s_mov_b32 m0, 115712
    s_add_u32 s60, s54, 28672
    buffer_load_dwordx4 v12, s[68:71], s60 offen nt lds
    s_mov_b32 m0, 116736
    s_add_u32 s60, s54, 57344
    buffer_load_dwordx4 v12, s[68:71], s60 offen nt lds
    s_mov_b32 m0, 117760
    s_add_u32 s60, s54, 86016
    buffer_load_dwordx4 v12, s[68:71], s60 offen nt lds
    s_mov_b32 m0, 118784
    s_add_u32 s60, s54, 114688
    buffer_load_dwordx4 v12, s[68:71], s60 offen nt lds
    s_mov_b32 m0, 119808
    s_add_u32 s60, s54, 143360
    buffer_load_dwordx4 v12, s[68:71], s60 offen nt lds
    s_mov_b32 m0, 120832
    s_add_u32 s60, s54, 172032
    buffer_load_dwordx4 v12, s[68:71], s60 offen nt lds
    s_mov_b32 m0, 121856
    s_add_u32 s60, s54, 200704
    buffer_load_dwordx4 v12, s[68:71], s60 offen nt lds
    s_waitcnt vmcnt(24)
    s_mov_b64 exec, 1
    v_mov_b32 v16, 2
    ds_write_b32 v15, v16 offset:12
    s_mov_b64 exec, -1
    s_mov_b32 m0, 122880
    s_add_u32 s60, s54, 229376
    buffer_load_dwordx4 v12, s[68:71], s60 offen nt lds
    s_mov_b32 m0, 123904
    s_add_u32 s60, s54, 258048
    buffer_load_dwordx4 v12, s[68:71], s60 offen nt lds
    s_mov_b32 m0, 124928
    s_add_u32 s60, s54, 286720
    buffer_load_dwordx4 v12, s[68:71], s60 offen nt lds
    s_mov_b32 m0, 125952
    s_add_u32 s60, s54, 315392
    buffer_load_dwordx4 v12, s[68:71], s60 offen nt lds
    s_mov_b32 m0, 126976
    s_add_u32 s60, s54, 344064
    buffer_load_dwordx4 v12, s[68:71], s60 offen nt lds
    s_mov_b32 m0, 128000
    s_add_u32 s60, s54, 372736
    buffer_load_dwordx4 v12, s[68:71], s60 offen nt lds
    s_waitcnt vmcnt(24)
    s_mov_b32 m0, 147456
    s_add_u32 s60, s57, 0
    buffer_load_dwordx4 v13, s[44:47], s60 offen nt lds
    s_mov_b32 m0, 148480
    s_add_u32 s60, s57, 7168
    buffer_load_dwordx4 v13, s[44:47], s60 offen nt lds
    s_mov_b32 m0, 149504
    s_add_u32 s60, s57, 14336
    buffer_load_dwordx4 v13, s[44:47], s60 offen nt lds
    s_mov_b32 m0, 150528
    s_add_u32 s60, s57, 21504
    buffer_load_dwordx4 v13, s[44:47], s60 offen nt lds
    s_mov_b32 m0, 151552
    s_add_u32 s60, s57, 28672
    buffer_load_dwordx4 v13, s[44:47], s60 offen nt lds
    s_mov_b32 m0, 152576
    s_add_u32 s60, s57, 35840
    buffer_load_dwordx4 v13, s[44:47], s60 offen nt lds
    s_mov_b32 m0, 153600
    s_add_u32 s60, s57, 43008
    buffer_load_dwordx4 v13, s[44:47], s60 offen nt lds
    s_mov_b32 m0, 154624
    s_add_u32 s60, s57, 50176
    buffer_load_dwordx4 v13, s[44:47], s60 offen nt lds
    s_waitcnt vmcnt(24)
    s_mov_b64 exec, 1
    v_mov_b32 v16, 3
    ds_write_b32 v15, v16 offset:12
    s_mov_b64 exec, -1
    s_add_u32 s61, s59, 4
    s_and_b32 s61, s61, 15
    s_lshl_b32 s61, s61, 13
    s_add_u32 s61, s61, s49
    s_mov_b32 m0, 32768
    s_add_u32 s60, s61, 0
    buffer_load_dwordx4 v2, s[32:35], s60 offen offset:0 nt lds
    buffer_load_dwordx4 v3, s[32:35], s60 offen offset:1024 nt lds
    buffer_load_dwordx4 v4, s[32:35], s60 offen offset:2048 nt lds
    buffer_load_dwordx4 v5, s[32:35], s60 offen offset:3072 nt lds
    s_mov_b32 m0, 36864
    s_add_u32 s60, s61, 4096
    buffer_load_dwordx4 v6, s[32:35], s60 offen offset:0 nt lds
    buffer_load_dwordx4 v7, s[32:35], s60 offen offset:1024 nt lds
    buffer_load_dwordx4 v8, s[32:35], s60 offen offset:2048 nt lds
    buffer_load_dwordx4 v9, s[32:35], s60 offen offset:3072 nt lds
    s_waitcnt vmcnt(24)
    s_mov_b64 exec, 1
    v_mov_b32 v16, 4
    ds_write_b32 v15, v16 offset:12
    s_mov_b64 exec, -1
    s_add_u32 s61, s59, 5
    s_and_b32 s61, s61, 15
    s_lshl_b32 s61, s61, 13
    s_add_u32 s61, s61, s49
    s_mov_b32 m0, 40960
    s_add_u32 s60, s61, 0
    buffer_load_dwordx4 v2, s[32:35], s60 offen offset:0 nt lds
    buffer_load_dwordx4 v3, s[32:35], s60 offen offset:1024 nt lds
    buffer_load_dwordx4 v4, s[32:35], s60 offen offset:2048 nt lds
    buffer_load_dwordx4 v5, s[32:35], s60 offen offset:3072 nt lds
    s_mov_b32 m0, 45056
    s_add_u32 s60, s61, 4096
    buffer_load_dwordx4 v6, s[32:35], s60 offen offset:0 nt lds
    buffer_load_dwordx4 v7, s[32:35], s60 offen offset:1024 nt lds
    buffer_load_dwordx4 v8, s[32:35], s60 offen offset:2048 nt lds
    buffer_load_dwordx4 v9, s[32:35], s60 offen offset:3072 nt lds
    s_waitcnt vmcnt(24)
    s_mov_b64 exec, 1
    v_mov_b32 v16, 1
    ds_write_b32 v15, v16 offset:8
    s_mov_b64 exec, -1
    s_add_u32 s61, s59, 6
    s_and_b32 s61, s61, 15
    s_lshl_b32 s61, s61, 13
    s_add_u32 s61, s61, s49
    s_mov_b32 m0, 49152
    s_add_u32 s60, s61, 0
    buffer_load_dwordx4 v2, s[32:35], s60 offen offset:0 nt lds
    buffer_load_dwordx4 v3, s[32:35], s60 offen offset:1024 nt lds
    buffer_load_dwordx4 v4, s[32:35], s60 offen offset:2048 nt lds
    buffer_load_dwordx4 v5, s[32:35], s60 offen offset:3072 nt lds
    s_mov_b32 m0, 53248
    s_add_u32 s60, s61, 4096
    buffer_load_dwordx4 v6, s[32:35], s60 offen offset:0 nt lds
    buffer_load_dwordx4 v7, s[32:35], s60 offen offset:1024 nt lds
    buffer_load_dwordx4 v8, s[32:35], s60 offen offset:2048 nt lds
    buffer_load_dwordx4 v9, s[32:35], s60 offen offset:3072 nt lds
    s_waitcnt vmcnt(24)
    s_mov_b64 exec, 1
    v_mov_b32 v16, 1
    ds_write_b32 v15, v16 offset:16
    s_mov_b64 exec, -1
    s_add_u32 s61, s59, 7
    s_and_b32 s61, s61, 15
    s_lshl_b32 s61, s61, 13
    s_add_u32 s61, s61, s49
    s_mov_b32 m0, 57344
    s_add_u32 s60, s61, 0
    buffer_load_dwordx4 v2, s[32:35], s60 offen offset:0 nt lds
    buffer_load_dwordx4 v3, s[32:35], s60 offen offset:1024 nt lds
    buffer_load_dwordx4 v4, s[32:35], s60 offen offset:2048 nt lds
    buffer_load_dwordx4 v5, s[32:35], s60 offen offset:3072 nt lds
    s_mov_b32 m0, 61440
    s_add_u32 s60, s61, 4096
    buffer_load_dwordx4 v6, s[32:35], s60 offen offset:0 nt lds
    buffer_load_dwordx4 v7, s[32:35], s60 offen offset:1024 nt lds
    buffer_load_dwordx4 v8, s[32:35], s60 offen offset:2048 nt lds
    buffer_load_dwordx4 v9, s[32:35], s60 offen offset:3072 nt lds
    s_waitcnt vmcnt(24)
    s_mov_b64 exec, 1
    v_mov_b32 v16, 5
    ds_write_b32 v15, v16 offset:12
    s_mov_b64 exec, -1
    s_add_u32 s61, s59, 8
    s_and_b32 s61, s61, 15
    s_lshl_b32 s61, s61, 13
    s_add_u32 s61, s61, s49
    s_mov_b32 m0, 65536
    s_add_u32 s60, s61, 0
    buffer_load_dwordx4 v2, s[32:35], s60 offen offset:0 nt lds
    buffer_load_dwordx4 v3, s[32:35], s60 offen offset:1024 nt lds
    buffer_load_dwordx4 v4, s[32:35], s60 offen offset:2048 nt lds
    buffer_load_dwordx4 v5, s[32:35], s60 offen offset:3072 nt lds
    s_mov_b32 m0, 69632
    s_add_u32 s60, s61, 4096
    buffer_load_dwordx4 v6, s[32:35], s60 offen offset:0 nt lds
    buffer_load_dwordx4 v7, s[32:35], s60 offen offset:1024 nt lds
    buffer_load_dwordx4 v8, s[32:35], s60 offen offset:2048 nt lds
    buffer_load_dwordx4 v9, s[32:35], s60 offen offset:3072 nt lds
    s_waitcnt vmcnt(24)
    s_mov_b64 exec, 1
    v_mov_b32 v16, 6
    ds_write_b32 v15, v16 offset:12
    s_mov_b64 exec, -1
    s_add_u32 s61, s59, 9
    s_and_b32 s61, s61, 15
    s_lshl_b32 s61, s61, 13
    s_add_u32 s61, s61, s49
    s_mov_b32 m0, 73728
    s_add_u32 s60, s61, 0
    buffer_load_dwordx4 v2, s[32:35], s60 offen offset:0 nt lds
    buffer_load_dwordx4 v3, s[32:35], s60 offen offset:1024 nt lds
    buffer_load_dwordx4 v4, s[32:35], s60 offen offset:2048 nt lds
    buffer_load_dwordx4 v5, s[32:35], s60 offen offset:3072 nt lds
    s_mov_b32 m0, 77824
    s_add_u32 s60, s61, 4096
    buffer_load_dwordx4 v6, s[32:35], s60 offen offset:0 nt lds
    buffer_load_dwordx4 v7, s[32:35], s60 offen offset:1024 nt lds
    buffer_load_dwordx4 v8, s[32:35], s60 offen offset:2048 nt lds
    buffer_load_dwordx4 v9, s[32:35], s60 offen offset:3072 nt lds
    s_waitcnt vmcnt(24)
    s_mov_b64 exec, 1
    v_mov_b32 v16, 7
    ds_write_b32 v15, v16 offset:12
    s_mov_b64 exec, -1
    s_add_u32 s61, s59, 10
    s_and_b32 s61, s61, 15
    s_lshl_b32 s61, s61, 13
    s_add_u32 s61, s61, s49
    s_mov_b32 m0, 81920
    s_add_u32 s60, s61, 0
    buffer_load_dwordx4 v2, s[32:35], s60 offen offset:0 nt lds
    buffer_load_dwordx4 v3, s[32:35], s60 offen offset:1024 nt lds
    buffer_load_dwordx4 v4, s[32:35], s60 offen offset:2048 nt lds
    buffer_load_dwordx4 v5, s[32:35], s60 offen offset:3072 nt lds
    s_mov_b32 m0, 86016
    s_add_u32 s60, s61, 4096
    buffer_load_dwordx4 v6, s[32:35], s60 offen offset:0 nt lds
    buffer_load_dwordx4 v7, s[32:35], s60 offen offset:1024 nt lds
    buffer_load_dwordx4 v8, s[32:35], s60 offen offset:2048 nt lds
    buffer_load_dwordx4 v9, s[32:35], s60 offen offset:3072 nt lds
    s_waitcnt vmcnt(24)
    s_mov_b64 exec, 1
    v_mov_b32 v16, 8
    ds_write_b32 v15, v16 offset:12
    s_mov_b64 exec, -1
    s_add_u32 s61, s59, 11
    s_and_b32 s61, s61, 15
    s_lshl_b32 s61, s61, 13
    s_add_u32 s61, s61, s49
    s_mov_b32 m0, 90112
    s_add_u32 s60, s61, 0
    buffer_load_dwordx4 v2, s[32:35], s60 offen offset:0 nt lds
    buffer_load_dwordx4 v3, s[32:35], s60 offen offset:1024 nt lds
    buffer_load_dwordx4 v4, s[32:35], s60 offen offset:2048 nt lds
    buffer_load_dwordx4 v5, s[32:35], s60 offen offset:3072 nt lds
    s_mov_b32 m0, 94208
    s_add_u32 s60, s61, 4096
    buffer_load_dwordx4 v6, s[32:35], s60 offen offset:0 nt lds
    buffer_load_dwordx4 v7, s[32:35], s60 offen offset:1024 nt lds
    buffer_load_dwordx4 v8, s[32:35], s60 offen offset:2048 nt lds
    buffer_load_dwordx4 v9, s[32:35], s60 offen offset:3072 nt lds
    s_waitcnt vmcnt(24)
    s_mov_b64 exec, 1
    v_mov_b32 v16, 9
    ds_write_b32 v15, v16 offset:12
    s_mov_b64 exec, -1
    s_mov_b32 s98, 262144
L_w_1:
    ds_read_b32 v17, v15 offset:32
    s_sub_u32 s98, s98, 1
    s_cbranch_scc1 L_wd_2
    s_waitcnt lgkmcnt(0)
    v_readfirstlane_b32 s99, v17
    s_cmp_ge_u32 s99, 1
    s_cbranch_scc0 L_w_1
L_wd_2:
    s_waitcnt lgkmcnt(0)
    s_add_u32 s61, s59, 12
    s_and_b32 s61, s61, 15
    s_lshl_b32 s61, s61, 13
    s_add_u32 s61, s61, s49
    s_mov_b32 m0, 0
    s_add_u32 s60, s61, 0
    buffer_load_dwordx4 v2, s[32:35], s60 offen offset:0 nt lds
    buffer_load_dwordx4 v3, s[32:35], s60 offen offset:1024 nt lds
    buffer_load_dwordx4 v4, s[32:35], s60 offen offset:2048 nt lds
    buffer_load_dwordx4 v5, s[32:35], s60 offen offset:3072 nt lds
    s_mov_b32 m0, 4096
    s_add_u32 s60, s61, 4096
    buffer_load_dwordx4 v6, s[32:35], s60 offen offset:0 nt lds
    buffer_load_dwordx4 v7, s[32:35], s60 offen offset:1024 nt lds
    buffer_load_dwordx4 v8, s[32:35], s60 offen offset:2048 nt lds
    buffer_load_dwordx4 v9, s[32:35], s60 offen offset:3072 nt lds
    s_waitcnt vmcnt(24)
    s_mov_b64 exec, 1
    v_mov_b32 v16, 10
    ds_write_b32 v15, v16 offset:12
    s_mov_b64 exec, -1
    s_mov_b32 s98, 262144
L_w_3:
    ds_read_b32 v17, v15 offset:36
    s_sub_u32 s98, s98, 1
    s_cbranch_scc1 L_wd_4
    s_waitcnt lgkmcnt(0)
    v_readfirstlane_b32 s99, v17
    s_cmp_ge_u32 s99, 1
    s_cbranch_scc0 L_w_3
L_wd_4:
    s_waitcnt lgkmcnt(0)
    s_add_u32 s61, s59, 13
    s_and_b32 s61, s61, 15
    s_lshl_b32 s61, s61, 13
    s_add_u32 s61, s61, s49
    s_mov_b32 m0, 8192
    s_add_u32 s60, s61, 0
    buffer_load_dwordx4 v2, s[32:35], s60 offen offset:0 nt lds
    buffer_load_dwordx4 v3, s[32:35], s60 offen offset:1024 nt lds
    buffer_load_dwordx4 v4, s[32:35], s60 offen offset:2048 nt lds
    buffer_load_dwordx4 v5, s[32:35], s60 offen offset:3072 nt lds
    s_mov_b32 m0, 12288
    s_add_u32 s60, s61, 4096
    buffer_load_dwordx4 v6, s[32:35], s60 offen offset:0 nt lds
    buffer_load_dwordx4 v7, s[32:35], s60 offen offset:1024 nt lds
    buffer_load_dwordx4 v8, s[32:35], s60 offen offset:2048 nt lds
    buffer_load_dwordx4 v9, s[32:35], s60 offen offset:3072 nt lds
    s_waitcnt vmcnt(24)
    s_mov_b64 exec, 1
    v_mov_b32 v16, 11
    ds_write_b32 v15, v16 offset:12
    s_mov_b64 exec, -1
    s_mov_b32 s98, 262144
L_w_5:
    ds_read_b32 v17, v15 offset:40
    s_sub_u32 s98, s98, 1
    s_cbranch_scc1 L_wd_6
    s_waitcnt lgkmcnt(0)
    v_readfirstlane_b32 s99, v17
    s_cmp_ge_u32 s99, 1
    s_cbranch_scc0 L_w_5
L_wd_6:
    s_waitcnt lgkmcnt(0)
    s_add_u32 s61, s59, 14
    s_and_b32 s61, s61, 15
    s_lshl_b32 s61, s61, 13
    s_add_u32 s61, s61, s49
    s_mov_b32 m0, 16384
    s_add_u32 s60, s61, 0
    buffer_load_dwordx4 v2, s[32:35], s60 offen offset:0 nt lds
    buffer_load_dwordx4 v3, s[32:35], s60 offen offset:1024 nt lds
    buffer_load_dwordx4 v4, s[32:35], s60 offen offset:2048 nt lds
    buffer_load_dwordx4 v5, s[32:35], s60 offen offset:3072 nt lds
    s_mov_b32 m0, 20480
    s_add_u32 s60, s61, 4096
    buffer_load_dwordx4 v6, s[32:35], s60 offen offset:0 nt lds
    buffer_load_dwordx4 v7, s[32:35], s60 offen offset:1024 nt lds
    buffer_load_dwordx4 v8, s[32:35], s60 offen offset:2048 nt lds
    buffer_load_dwordx4 v9, s[32:35], s60 offen offset:3072 nt lds
    s_waitcnt vmcnt(24)
    s_mov_b64 exec, 1
    v_mov_b32 v16, 12
    ds_write_b32 v15, v16 offset:12
    s_mov_b64 exec, -1
    s_mov_b32 s98, 262144
L_w_7:
    ds_read_b32 v17, v15 offset:44
    s_sub_u32 s98, s98, 1
    s_cbranch_scc1 L_wd_8
    s_waitcnt lgkmcnt(0)
    v_readfirstlane_b32 s99, v17
    s_cmp_ge_u32 s99, 1
    s_cbranch_scc0 L_w_7
L_wd_8:
    s_waitcnt lgkmcnt(0)
    s_add_u32 s61, s59, 15
    s_and_b32 s61, s61, 15
    s_lshl_b32 s61, s61, 13
    s_add_u32 s61, s61, s49
    s_mov_b32 m0, 24576
    s_add_u32 s60, s61, 0
    buffer_load_dwordx4 v2, s[32:35], s60 offen offset:0 nt lds
    buffer_load_dwordx4 v3, s[32:35], s60 offen offset:1024 nt lds
    buffer_load_dwordx4 v4, s[32:35], s60 offen offset:2048 nt lds
    buffer_load_dwordx4 v5, s[32:35], s60 offen offset:3072 nt lds
    s_mov_b32 m0, 28672
    s_add_u32 s60, s61, 4096
    buffer_load_dwordx4 v6, s[32:35], s60 offen offset:0 nt lds
    buffer_load_dwordx4 v7, s[32:35], s60 offen offset:1024 nt lds
    buffer_load_dwordx4 v8, s[32:35], s60 offen offset:2048 nt lds
    buffer_load_dwordx4 v9, s[32:35], s60 offen offset:3072 nt lds
    s_waitcnt vmcnt(24)
    s_mov_b64 exec, 1
    v_mov_b32 v16, 13
    ds_write_b32 v15, v16 offset:12
    s_mov_b64 exec, -1
    s_mov_b32 s98, 262144
L_w_9:
    ds_read_b32 v17, v15 offset:32
    s_sub_u32 s98, s98, 1
    s_cbranch_scc1 L_wd_10
    s_waitcnt lgkmcnt(0)
    v_readfirstlane_b32 s99, v17
    s_cmp_ge_u32 s99, 2
    s_cbranch_scc0 L_w_9
L_wd_10:
    s_waitcnt lgkmcnt(0)
    s_add_u32 s61, s59, 0
    s_and_b32 s61, s61, 15
    s_lshl_b32 s61, s61, 13
    s_add_u32 s61, s61, s49
    s_mov_b32 m0, 32768
    s_add_u32 s60, s61, 0
    buffer_load_dwordx4 v24, s[36:39], s60 offen offset:0 nt lds
    buffer_load_dwordx4 v25, s[36:39], s60 offen offset:1024 nt lds
    buffer_load_dwordx4 v26, s[36:39], s60 offen offset:2048 nt lds
    buffer_load_dwordx4 v27, s[36:39], s60 offen offset:3072 nt lds
    s_mov_b32 m0, 36864
    s_add_u32 s60, s61, 4096
    buffer_load_dwordx4 v24, s[36:39], s60 offen offset:0 nt lds
    buffer_load_dwordx4 v25, s[36:39], s60 offen offset:1024 nt lds
    buffer_load_dwordx4 v26, s[36:39], s60 offen offset:2048 nt lds
    buffer_load_dwordx4 v27, s[36:39], s60 offen offset:3072 nt lds
    s_waitcnt vmcnt(24)
    s_mov_b64 exec, 1
    v_mov_b32 v16, 14
    ds_write_b32 v15, v16 offset:12
    s_mov_b64 exec, -1
    s_mov_b32 s98, 262144
L_w_11:
    ds_read_b32 v17, v15 offset:36
    s_sub_u32 s98, s98, 1
    s_cbranch_scc1 L_wd_12
    s_waitcnt lgkmcnt(0)
    v_readfirstlane_b32 s99, v17
    s_cmp_ge_u32 s99, 2
    s_cbranch_scc0 L_w_11
L_wd_12:
    s_waitcnt lgkmcnt(0)
    s_add_u32 s61, s59, 1
    s_and_b32 s61, s61, 15
    s_lshl_b32 s61, s61, 13
    s_add_u32 s61, s61, s49
    s_mov_b32 m0, 40960
    s_add_u32 s60, s61, 0
    buffer_load_dwordx4 v24, s[36:39], s60 offen offset:0 nt lds
    buffer_load_dwordx4 v25, s[36:39], s60 offen offset:1024 nt lds
    buffer_load_dwordx4 v26, s[36:39], s60 offen offset:2048 nt lds
    buffer_load_dwordx4 v27, s[36:39], s60 offen offset:3072 nt lds
    s_mov_b32 m0, 45056
    s_add_u32 s60, s61, 4096
    buffer_load_dwordx4 v24, s[36:39], s60 offen offset:0 nt lds
    buffer_load_dwordx4 v25, s[36:39], s60 offen offset:1024 nt lds
    buffer_load_dwordx4 v26, s[36:39], s60 offen offset:2048 nt lds
    buffer_load_dwordx4 v27, s[36:39], s60 offen offset:3072 nt lds
    s_waitcnt vmcnt(24)
    s_mov_b64 exec, 1
    v_mov_b32 v16, 15
    ds_write_b32 v15, v16 offset:12
    s_mov_b64 exec, -1
    s_mov_b32 s98, 262144
L_w_13:
    ds_read_b32 v17, v15 offset:40
    s_sub_u32 s98, s98, 1
    s_cbranch_scc1 L_wd_14
    s_waitcnt lgkmcnt(0)
    v_readfirstlane_b32 s99, v17
    s_cmp_ge_u32 s99, 2
    s_cbranch_scc0 L_w_13
L_wd_14:
    s_waitcnt lgkmcnt(0)
    s_add_u32 s61, s59, 2
    s_and_b32 s61, s61, 15
    s_lshl_b32 s61, s61, 13
    s_add_u32 s61, s61, s49
    s_mov_b32 m0, 49152
    s_add_u32 s60, s61, 0
    buffer_load_dwordx4 v24, s[36:39], s60 offen offset:0 nt lds
    buffer_load_dwordx4 v25, s[36:39], s60 offen offset:1024 nt lds
    buffer_load_dwordx4 v26, s[36:39], s60 offen offset:2048 nt lds
    buffer_load_dwordx4 v27, s[36:39], s60 offen offset:3072 nt lds
    s_mov_b32 m0, 53248
    s_add_u32 s60, s61, 4096
    buffer_load_dwordx4 v24, s[36:39], s60 offen offset:0 nt lds
    buffer_load_dwordx4 v25, s[36:39], s60 offen offset:1024 nt lds
    buffer_load_dwordx4 v26, s[36:39], s60 offen offset:2048 nt lds
    buffer_load_dwordx4 v27, s[36:39], s60 offen offset:3072 nt lds
    s_waitcnt vmcnt(24)
    s_mov_b64 exec, 1
    v_mov_b32 v16, 16
    ds_write_b32 v15, v16 offset:12
    s_mov_b64 exec, -1
    s_mov_b32 s98, 262144
L_w_15:
    ds_read_b32 v17, v15 offset:44
    s_sub_u32 s98, s98, 1
    s_cbranch_scc1 L_wd_16
    s_waitcnt lgkmcnt(0)
    v_readfirstlane_b32 s99, v17
    s_cmp_ge_u32 s99, 2
    s_cbranch_scc0 L_w_15
L_wd_16:
    s_waitcnt lgkmcnt(0)
    s_add_u32 s61, s59, 3
    s_and_b32 s61, s61, 15
    s_lshl_b32 s61, s61, 13
    s_add_u32 s61, s61, s49
    s_mov_b32 m0, 57344
    s_add_u32 s60, s61, 0
    buffer_load_dwordx4 v24, s[36:39], s60 offen offset:0 nt lds
    buffer_load_dwordx4 v25, s[36:39], s60 offen offset:1024 nt lds
    buffer_load_dwordx4 v26, s[36:39], s60 offen offset:2048 nt lds
    buffer_load_dwordx4 v27, s[36:39], s60 offen offset:3072 nt lds
    s_mov_b32 m0, 61440
    s_add_u32 s60, s61, 4096
    buffer_load_dwordx4 v24, s[36:39], s60 offen offset:0 nt lds
    buffer_load_dwordx4 v25, s[36:39], s60 offen offset:1024 nt lds
    buffer_load_dwordx4 v26, s[36:39], s60 offen offset:2048 nt lds
    buffer_load_dwordx4 v27, s[36:39], s60 offen offset:3072 nt lds
    s_waitcnt vmcnt(24)
    s_mov_b64 exec, 1
    v_mov_b32 v16, 1
    ds_write_b32 v15, v16 offset:20
    s_mov_b64 exec, -1
    s_mov_b32 s98, 262144
L_w_17:
    ds_read_b32 v17, v15 offset:32
    s_sub_u32 s98, s98, 1
    s_cbranch_scc1 L_wd_18
    s_waitcnt lgkmcnt(0)
    v_readfirstlane_b32 s99, v17
    s_cmp_ge_u32 s99, 3
    s_cbranch_scc0 L_w_17
L_wd_18:
    s_waitcnt lgkmcnt(0)
    s_add_u32 s61, s59, 4
    s_and_b32 s61, s61, 15
    s_lshl_b32 s61, s61, 13
    s_add_u32 s61, s61, s49
    s_mov_b32 m0, 65536
    s_add_u32 s60, s61, 0
    buffer_load_dwordx4 v24, s[36:39], s60 offen offset:0 nt lds
    buffer_load_dwordx4 v25, s[36:39], s60 offen offset:1024 nt lds
    buffer_load_dwordx4 v26, s[36:39], s60 offen offset:2048 nt lds
    buffer_load_dwordx4 v27, s[36:39], s60 offen offset:3072 nt lds
    s_mov_b32 m0, 69632
    s_add_u32 s60, s61, 4096
    buffer_load_dwordx4 v24, s[36:39], s60 offen offset:0 nt lds
    buffer_load_dwordx4 v25, s[36:39], s60 offen offset:1024 nt lds
    buffer_load_dwordx4 v26, s[36:39], s60 offen offset:2048 nt lds
    buffer_load_dwordx4 v27, s[36:39], s60 offen offset:3072 nt lds
    s_waitcnt vmcnt(24)
    s_mov_b64 exec, 1
    v_mov_b32 v16, 2
    ds_write_b32 v15, v16 offset:20
    s_mov_b64 exec, -1
    s_mov_b32 s98, 262144
L_w_19:
    ds_read_b32 v17, v15 offset:36
    s_sub_u32 s98, s98, 1
    s_cbranch_scc1 L_wd_20
    s_waitcnt lgkmcnt(0)
    v_readfirstlane_b32 s99, v17
    s_cmp_ge_u32 s99, 3
    s_cbranch_scc0 L_w_19
L_wd_20:
    s_waitcnt lgkmcnt(0)
    s_add_u32 s61, s59, 5
    s_and_b32 s61, s61, 15
    s_lshl_b32 s61, s61, 13
    s_add_u32 s61, s61, s49
    s_mov_b32 m0, 73728
    s_add_u32 s60, s61, 0
    buffer_load_dwordx4 v24, s[36:39], s60 offen offset:0 nt lds
    buffer_load_dwordx4 v25, s[36:39], s60 offen offset:1024 nt lds
    buffer_load_dwordx4 v26, s[36:39], s60 offen offset:2048 nt lds
    buffer_load_dwordx4 v27, s[36:39], s60 offen offset:3072 nt lds
    s_mov_b32 m0, 77824
    s_add_u32 s60, s61, 4096
    buffer_load_dwordx4 v24, s[36:39], s60 offen offset:0 nt lds
    buffer_load_dwordx4 v25, s[36:39], s60 offen offset:1024 nt lds
    buffer_load_dwordx4 v26, s[36:39], s60 offen offset:2048 nt lds
    buffer_load_dwordx4 v27, s[36:39], s60 offen offset:3072 nt lds
    s_waitcnt vmcnt(24)
    s_mov_b64 exec, 1
    v_mov_b32 v16, 3
    ds_write_b32 v15, v16 offset:20
    s_mov_b64 exec, -1
    s_mov_b32 s98, 262144
L_w_21:
    ds_read_b32 v17, v15 offset:40
    s_sub_u32 s98, s98, 1
    s_cbranch_scc1 L_wd_22
    s_waitcnt lgkmcnt(0)
    v_readfirstlane_b32 s99, v17
    s_cmp_ge_u32 s99, 3
    s_cbranch_scc0 L_w_21
L_wd_22:
    s_waitcnt lgkmcnt(0)
    s_add_u32 s61, s59, 6
    s_and_b32 s61, s61, 15
    s_lshl_b32 s61, s61, 13
    s_add_u32 s61, s61, s49
    s_mov_b32 m0, 81920
    s_add_u32 s60, s61, 0
    buffer_load_dwordx4 v24, s[36:39], s60 offen offset:0 nt lds
    buffer_load_dwordx4 v25, s[36:39], s60 offen offset:1024 nt lds
    buffer_load_dwordx4 v26, s[36:39], s60 offen offset:2048 nt lds
    buffer_load_dwordx4 v27, s[36:39], s60 offen offset:3072 nt lds
    s_mov_b32 m0, 86016
    s_add_u32 s60, s61, 4096
    buffer_load_dwordx4 v24, s[36:39], s60 offen offset:0 nt lds
    buffer_load_dwordx4 v25, s[36:39], s60 offen offset:1024 nt lds
    buffer_load_dwordx4 v26, s[36:39], s60 offen offset:2048 nt lds
    buffer_load_dwordx4 v27, s[36:39], s60 offen offset:3072 nt lds
    s_waitcnt vmcnt(24)
    s_mov_b64 exec, 1
    v_mov_b32 v16, 4
    ds_write_b32 v15, v16 offset:20
    s_mov_b64 exec, -1
    s_mov_b32 s98, 262144
L_w_23:
    ds_read_b32 v17, v15 offset:44
    s_sub_u32 s98, s98, 1
    s_cbranch_scc1 L_wd_24
    s_waitcnt lgkmcnt(0)
    v_readfirstlane_b32 s99, v17
    s_cmp_ge_u32 s99, 3
    s_cbranch_scc0 L_w_23
L_wd_24:
    s_waitcnt lgkmcnt(0)
    s_add_u32 s61, s59, 7
    s_and_b32 s61, s61, 15
    s_lshl_b32 s61, s61, 13
    s_add_u32 s61, s61, s49
    s_mov_b32 m0, 90112
    s_add_u32 s60, s61, 0
    buffer_load_dwordx4 v24, s[36:39], s60 offen offset:0 nt lds
    buffer_load_dwordx4 v25, s[36:39], s60 offen offset:1024 nt lds
    buffer_load_dwordx4 v26, s[36:39], s60 offen offset:2048 nt lds
    buffer_load_dwordx4 v27, s[36:39], s60 offen offset:3072 nt lds
    s_mov_b32 m0, 94208
    s_add_u32 s60, s61, 4096
    buffer_load_dwordx4 v24, s[36:39], s60 offen offset:0 nt lds
    buffer_load_dwordx4 v25, s[36:39], s60 offen offset:1024 nt lds
    buffer_load_dwordx4 v26, s[36:39], s60 offen offset:2048 nt lds
    buffer_load_dwordx4 v27, s[36:39], s60 offen offset:3072 nt lds
    s_waitcnt vmcnt(24)
    s_mov_b64 exec, 1
    v_mov_b32 v16, 5
    ds_write_b32 v15, v16 offset:20
    s_mov_b64 exec, -1
    s_mov_b32 s98, 262144
L_w_25:
    ds_read_b32 v17, v15 offset:32
    s_sub_u32 s98, s98, 1
    s_cbranch_scc1 L_wd_26
    s_waitcnt lgkmcnt(0)
    v_readfirstlane_b32 s99, v17
    s_cmp_ge_u32 s99, 4
    s_cbranch_scc0 L_w_25
L_wd_26:
    s_waitcnt lgkmcnt(0)
    s_add_u32 s61, s59, 8
    s_and_b32 s61, s61, 15
    s_lshl_b32 s61, s61, 13
    s_add_u32 s61, s61, s49
    s_mov_b32 m0, 0
    s_add_u32 s60, s61, 0
    buffer_load_dwordx4 v24, s[36:39], s60 offen offset:0 nt lds
    buffer_load_dwordx4 v25, s[36:39], s60 offen offset:1024 nt lds
    buffer_load_dwordx4 v26, s[36:39], s60 offen offset:2048 nt lds
    buffer_load_dwordx4 v27, s[36:39], s60 offen offset:3072 nt lds
    s_mov_b32 m0, 4096
    s_add_u32 s60, s61, 4096
    buffer_load_dwordx4 v24, s[36:39], s60 offen offset:0 nt lds
    buffer_load_dwordx4 v25, s[36:39], s60 offen offset:1024 nt lds
    buffer_load_dwordx4 v26, s[36:39], s60 offen offset:2048 nt lds
    buffer_load_dwordx4 v27, s[36:39], s60 offen offset:3072 nt lds
    s_waitcnt vmcnt(32)
    s_mov_b32 s98, 262144
L_w_27:
    ds_read_b32 v17, v15 offset:36
    s_sub_u32 s98, s98, 1
    s_cbranch_scc1 L_wd_28
    s_waitcnt lgkmcnt(0)
    v_readfirstlane_b32 s99, v17
    s_cmp_ge_u32 s99, 4
    s_cbranch_scc0 L_w_27
L_wd_28:
    s_waitcnt lgkmcnt(0)
    s_add_u32 s61, s59, 9
    s_and_b32 s61, s61, 15
    s_lshl_b32 s61, s61, 13
    s_add_u32 s61, s61, s49
    s_mov_b32 m0, 8192
    s_add_u32 s60, s61, 0
    buffer_load_dwordx4 v24, s[36:39], s60 offen offset:0 nt lds
    buffer_load_dwordx4 v25, s[36:39], s60 offen offset:1024 nt lds
    buffer_load_dwordx4 v26, s[36:39], s60 offen offset:2048 nt lds
    buffer_load_dwordx4 v27, s[36:39], s60 offen offset:3072 nt lds
    s_mov_b32 m0, 12288
    s_add_u32 s60, s61, 4096
    buffer_load_dwordx4 v24, s[36:39], s60 offen offset:0 nt lds
    buffer_load_dwordx4 v25, s[36:39], s60 offen offset:1024 nt lds
    buffer_load_dwordx4 v26, s[36:39], s60 offen offset:2048 nt lds
    buffer_load_dwordx4 v27, s[36:39], s60 offen offset:3072 nt lds
    s_waitcnt vmcnt(32)
    s_mov_b64 exec, 1
    v_mov_b32 v16, 6
    ds_write_b32 v15, v16 offset:20
    s_mov_b64 exec, -1
    s_mov_b32 s98, 262144
L_w_29:
    ds_read_b32 v17, v15 offset:40
    s_sub_u32 s98, s98, 1
    s_cbranch_scc1 L_wd_30
    s_waitcnt lgkmcnt(0)
    v_readfirstlane_b32 s99, v17
    s_cmp_ge_u32 s99, 4
    s_cbranch_scc0 L_w_29
L_wd_30:
    s_waitcnt lgkmcnt(0)
    s_add_u32 s61, s59, 10
    s_and_b32 s61, s61, 15
    s_lshl_b32 s61, s61, 13
    s_add_u32 s61, s61, s49
    s_mov_b32 m0, 16384
    s_add_u32 s60, s61, 0
    buffer_load_dwordx4 v24, s[36:39], s60 offen offset:0 nt lds
    buffer_load_dwordx4 v25, s[36:39], s60 offen offset:1024 nt lds
    buffer_load_dwordx4 v26, s[36:39], s60 offen offset:2048 nt lds
    buffer_load_dwordx4 v27, s[36:39], s60 offen offset:3072 nt lds
    s_mov_b32 m0, 20480
    s_add_u32 s60, s61, 4096
    buffer_load_dwordx4 v24, s[36:39], s60 offen offset:0 nt lds
    buffer_load_dwordx4 v25, s[36:39], s60 offen offset:1024 nt lds
    buffer_load_dwordx4 v26, s[36:39], s60 offen offset:2048 nt lds
    buffer_load_dwordx4 v27, s[36:39], s60 offen offset:3072 nt lds
    s_waitcnt vmcnt(32)
    s_mov_b64 exec, 1
    v_mov_b32 v16, 7
    ds_write_b32 v15, v16 offset:20
    s_mov_b64 exec, -1
    s_mov_b32 s98, 262144
L_w_31:
    ds_read_b32 v17, v15 offset:44
    s_sub_u32 s98, s98, 1
    s_cbranch_scc1 L_wd_32
    s_waitcnt lgkmcnt(0)
    v_readfirstlane_b32 s99, v17
    s_cmp_ge_u32 s99, 4
    s_cbranch_scc0 L_w_31
L_wd_32:
    s_waitcnt lgkmcnt(0)
    s_add_u32 s61, s59, 11
    s_and_b32 s61, s61, 15
    s_lshl_b32 s61, s61, 13
    s_add_u32 s61, s61, s49
    s_mov_b32 m0, 24576
    s_add_u32 s60, s61, 0
    buffer_load_dwordx4 v24, s[36:39], s60 offen offset:0 nt lds
    buffer_load_dwordx4 v25, s[36:39], s60 offen offset:1024 nt lds
    buffer_load_dwordx4 v26, s[36:39], s60 offen offset:2048 nt lds
    buffer_load_dwordx4 v27, s[36:39], s60 offen offset:3072 nt lds
    s_mov_b32 m0, 28672
    s_add_u32 s60, s61, 4096
    buffer_load_dwordx4 v24, s[36:39], s60 offen offset:0 nt lds
    buffer_load_dwordx4 v25, s[36:39], s60 offen offset:1024 nt lds
    buffer_load_dwordx4 v26, s[36:39], s60 offen offset:2048 nt lds
    buffer_load_dwordx4 v27, s[36:39], s60 offen offset:3072 nt lds
    s_waitcnt vmcnt(32)
    s_mov_b64 exec, 1
    v_mov_b32 v16, 8
    ds_write_b32 v15, v16 offset:20
    s_mov_b64 exec, -1
    s_mov_b32 s98, 262144
L_w_33:
    ds_read_b32 v17, v15 offset:72
    s_sub_u32 s98, s98, 1
    s_cbranch_scc1 L_wd_34
    s_waitcnt lgkmcnt(0)
    v_readfirstlane_b32 s99, v17
    s_cmp_ge_u32 s99, 1
    s_cbranch_scc0 L_w_33
L_wd_34:
    s_waitcnt lgkmcnt(0)
    s_add_u32 s61, s59, 12
    s_and_b32 s61, s61, 15
    s_lshl_b32 s61, s61, 13
    s_add_u32 s61, s61, s49
    s_mov_b32 m0, 98304
    s_add_u32 s60, s61, 0
    buffer_load_dwordx4 v24, s[36:39], s60 offen offset:0 nt lds
    buffer_load_dwordx4 v25, s[36:39], s60 offen offset:1024 nt lds
    buffer_load_dwordx4 v26, s[36:39], s60 offen offset:2048 nt lds
    buffer_load_dwordx4 v27, s[36:39], s60 offen offset:3072 nt lds
    s_mov_b32 m0, 102400
    s_add_u32 s60, s61, 4096
    buffer_load_dwordx4 v24, s[36:39], s60 offen offset:0 nt lds
    buffer_load_dwordx4 v25, s[36:39], s60 offen offset:1024 nt lds
    buffer_load_dwordx4 v26, s[36:39], s60 offen offset:2048 nt lds
    buffer_load_dwordx4 v27, s[36:39], s60 offen offset:3072 nt lds
    s_waitcnt vmcnt(32)
    s_mov_b64 exec, 1
    v_mov_b32 v16, 9
    ds_write_b32 v15, v16 offset:20
    s_mov_b64 exec, -1
    s_add_u32 s61, s59, 13
    s_and_b32 s61, s61, 15
    s_lshl_b32 s61, s61, 13
    s_add_u32 s61, s61, s49
    s_mov_b32 m0, 106496
    s_add_u32 s60, s61, 0
    buffer_load_dwordx4 v24, s[36:39], s60 offen offset:0 nt lds
    buffer_load_dwordx4 v25, s[36:39], s60 offen offset:1024 nt lds
    buffer_load_dwordx4 v26, s[36:39], s60 offen offset:2048 nt lds
    buffer_load_dwordx4 v27, s[36:39], s60 offen offset:3072 nt lds
    s_mov_b32 m0, 110592
    s_add_u32 s60, s61, 4096
    buffer_load_dwordx4 v24, s[36:39], s60 offen offset:0 nt lds
    buffer_load_dwordx4 v25, s[36:39], s60 offen offset:1024 nt lds
    buffer_load_dwordx4 v26, s[36:39], s60 offen offset:2048 nt lds
    buffer_load_dwordx4 v27, s[36:39], s60 offen offset:3072 nt lds
    s_waitcnt vmcnt(32)
    s_mov_b64 exec, 1
    v_mov_b32 v16, 10
    ds_write_b32 v15, v16 offset:20
    s_mov_b64 exec, -1
    s_mov_b32 s98, 262144
L_w_35:
    ds_read_b32 v17, v15 offset:76
    s_sub_u32 s98, s98, 1
    s_cbranch_scc1 L_wd_36
    s_waitcnt lgkmcnt(0)
    v_readfirstlane_b32 s99, v17
    s_cmp_ge_u32 s99, 1
    s_cbranch_scc0 L_w_35
L_wd_36:
    s_waitcnt lgkmcnt(0)
    s_add_u32 s61, s59, 14
    s_and_b32 s61, s61, 15
    s_lshl_b32 s61, s61, 13
    s_add_u32 s61, s61, s49
    s_mov_b32 m0, 114688
    s_add_u32 s60, s61, 0
    buffer_load_dwordx4 v24, s[36:39], s60 offen offset:0 nt lds
    buffer_load_dwordx4 v25, s[36:39], s60 offen offset:1024 nt lds
    buffer_load_dwordx4 v26, s[36:39], s60 offen offset:2048 nt lds
    buffer_load_dwordx4 v27, s[36:39], s60 offen offset:3072 nt lds
    s_mov_b32 m0, 118784
    s_add_u32 s60, s61, 4096
    buffer_load_dwordx4 v24, s[36:39], s60 offen offset:0 nt lds
    buffer_load_dwordx4 v25, s[36:39], s60 offen offset:1024 nt lds
    buffer_load_dwordx4 v26, s[36:39], s60 offen offset:2048 nt lds
    buffer_load_dwordx4 v27, s[36:39], s60 offen offset:3072 nt lds
    s_waitcnt vmcnt(32)
    s_mov_b64 exec, 1
    v_mov_b32 v16, 11
    ds_write_b32 v15, v16 offset:20
    s_mov_b64 exec, -1
    s_add_u32 s61, s59, 15
    s_and_b32 s61, s61, 15
    s_lshl_b32 s61, s61, 13
    s_add_u32 s61, s61, s49
    s_mov_b32 m0, 122880
    s_add_u32 s60, s61, 0
    buffer_load_dwordx4 v24, s[36:39], s60 offen offset:0 nt lds
    buffer_load_dwordx4 v25, s[36:39], s60 offen offset:1024 nt lds
    buffer_load_dwordx4 v26, s[36:39], s60 offen offset:2048 nt lds
    buffer_load_dwordx4 v27, s[36:39], s60 offen offset:3072 nt lds
    s_mov_b32 m0, 126976
    s_add_u32 s60, s61, 4096
    buffer_load_dwordx4 v24, s[36:39], s60 offen offset:0 nt lds
    buffer_load_dwordx4 v25, s[36:39], s60 offen offset:1024 nt lds
    buffer_load_dwordx4 v26, s[36:39], s60 offen offset:2048 nt lds
    buffer_load_dwordx4 v27, s[36:39], s60 offen offset:3072 nt lds
    s_waitcnt vmcnt(32)
    s_mov_b64 exec, 1
    v_mov_b32 v16, 12
    ds_write_b32 v15, v16 offset:20
    s_mov_b64 exec, -1
    s_mov_b32 m0, 131072
    s_add_u32 s60, s58, 0
    buffer_load_dwordx4 v13, s[64:67], s60 offen nt lds
    s_mov_b32 m0, 132096
    s_add_u32 s60, s58, 7168
    buffer_load_dwordx4 v13, s[64:67], s60 offen nt lds
    s_mov_b32 m0, 133120
    s_add_u32 s60, s58, 14336
    buffer_load_dwordx4 v13, s[64:67], s60 offen nt lds
    s_mov_b32 m0, 134144
    s_add_u32 s60, s58, 21504
    buffer_load_dwordx4 v13, s[64:67], s60 offen nt lds
    s_mov_b32 m0, 135168
    s_add_u32 s60, s58, 28672
    buffer_load_dwordx4 v13, s[64:67], s60 offen nt lds
    s_mov_b32 m0, 136192
    s_add_u32 s60, s58, 35840
    buffer_load_dwordx4 v13, s[64:67], s60 offen nt lds
    s_mov_b32 m0, 137216
    s_add_u32 s60, s58, 43008
    buffer_load_dwordx4 v13, s[64:67], s60 offen nt lds
    s_mov_b32 m0, 138240
    s_add_u32 s60, s58, 50176
    buffer_load_dwordx4 v13, s[64:67], s60 offen nt lds
    s_waitcnt vmcnt(32)
    s_mov_b64 exec, 1
    v_mov_b32 v16, 13
    ds_write_b32 v15, v16 offset:20
    s_mov_b64 exec, -1
    s_mov_b32 m0, 139264
    s_add_u32 s60, s58, 57344
    buffer_load_dwordx4 v13, s[64:67], s60 offen nt lds
    s_mov_b32 m0, 140288
    s_add_u32 s60, s58, 64512
    buffer_load_dwordx4 v13, s[64:67], s60 offen nt lds
    s_mov_b32 m0, 141312
    s_add_u32 s60, s58, 71680
    buffer_load_dwordx4 v13, s[64:67], s60 offen nt lds
    s_mov_b32 m0, 142336
    s_add_u32 s60, s58, 78848
    buffer_load_dwordx4 v13, s[64:67], s60 offen nt lds
    s_mov_b32 m0, 143360
    s_add_u32 s60, s58, 86016
    buffer_load_dwordx4 v13, s[64:67], s60 offen nt lds
    s_mov_b32 m0, 144384
    s_add_u32 s60, s58, 93184
    buffer_load_dwordx4 v13, s[64:67], s60 offen nt lds
    s_mov_b32 m0, 145408
    s_add_u32 s60, s58, 100352
    buffer_load_dwordx4 v13, s[64:67], s60 offen nt lds
    s_mov_b32 m0, 146432
    s_add_u32 s60, s58, 107520
    buffer_load_dwordx4 v13, s[64:67], s60 offen nt lds
    s_waitcnt vmcnt(32)
    s_mov_b64 exec, 1
    v_mov_b32 v16, 14
    ds_write_b32 v15, v16 offset:20
    s_mov_b64 exec, -1
    s_waitcnt vmcnt(24)
    s_mov_b64 exec, 1
    v_mov_b32 v16, 15
    ds_write_b32 v15, v16 offset:20
    s_mov_b64 exec, -1
    s_waitcnt vmcnt(16)
    s_mov_b64 exec, 1
    v_mov_b32 v16, 16
    ds_write_b32 v15, v16 offset:20
    s_mov_b64 exec, -1
    s_waitcnt vmcnt(0)
    s_mov_b64 exec, 1
    v_mov_b32 v16, 1
    ds_write_b32 v15, v16 offset:28
    s_mov_b64 exec, -1
    s_waitcnt lgkmcnt(0)
    s_endpgm
L_C:
    s_sub_u32 s32, s3, 1
    v_mov_b32 v4, 0
    v_mov_b32 v5, 0
    v_mov_b32 v6, 0
    v_mov_b32 v7, 0
    s_mul_i32 s34, s32, 896
    v_lshlrev_b32 v2, 4, v1
    v_add_u32 v2, s34, v2
    v_cmp_gt_u32 vcc, 56, v1
    s_mov_b64 s[36:37], vcc
    v_mul_u32_u24 v8, 37, v1
    v_lshrrev_b32 v8, 9, v8
    v_mul_u32_u24 v9, 14, v8
    v_sub_u32 v9, v1, v9
    v_lshrrev_b32 v3, 2, v9
    v_lshlrev_b32 v3, 6, v3
    v_and_b32 v10, 1, v9
    v_lshl_add_u32 v3, v10, 5, v3
    v_bfe_u32 v10, v9, 1, 1
    v_lshl_add_u32 v3, v10, 3, v3
    v_lshl_add_u32 v3, v8, 8, v3
    s_mul_i32 s34, s32, 1088
    s_add_u32 s34, s34, 155648
    v_add_u32 v3, s34, v3
    s_waitcnt lgkmcnt(0)
    s_mov_b64 exec, s[36:37]
    global_load_dwordx4 v[4:7], v2, s[8:9]
    s_mov_b64 exec, -1
    s_barrier
    s_add_u32 s92, s30, 0
    s_addc_u32 s93, s31, 0
    s_mov_b32 s94, 4194304
    s_mov_b32 s95, 0x20000
    s_mov_b32 s72, 0x7060500
    s_mov_b32 s73, 0x7060501
    s_mov_b32 s74, 0x7060502
    s_mov_b32 s75, 0x7060503
    s_mov_b32 s76, 0x0c0c0400
    s_mov_b32 s77, 0x04000c0c
    v_mov_b32 v15, 163712
    v_lshrrev_b32 v11, 4, v1
    v_and_b32 v12, 15, v1
    s_waitcnt vmcnt(0)
    v_lshlrev_b32 v16, 16, v4
    v_and_b32 v17, 0xffff0000, v4
    v_lshlrev_b32 v18, 16, v5
    v_and_b32 v19, 0xffff0000, v5
    v_lshlrev_b32 v20, 16, v6
    v_and_b32 v21, 0xffff0000, v6
    v_lshlrev_b32 v22, 16, v7
    v_and_b32 v23, 0xffff0000, v7
    v_add_f32 v24, v16, v17
    v_add_f32 v25, v18, v19
    v_add_f32 v26, v20, v21
    v_add_f32 v27, v22, v23
    v_add_f32 v24, v24, v25
    v_add_f32 v26, v26, v27
    v_add_f32 v24, v24, v26
    s_nop 1
    v_add_f32_dpp v24, v24, v24 row_ror:8 row_mask:0xf bank_mask:0xf
    s_nop 1
    v_add_f32_dpp v24, v24, v24 row_ror:4 row_mask:0xf bank_mask:0xf
    s_nop 1
    v_add_f32_dpp v24, v24, v24 row_ror:2 row_mask:0xf bank_mask:0xf
    s_nop 1
    v_add_f32_dpp v24, v24, v24 row_ror:1 row_mask:0xf bank_mask:0xf
    v_mov_b32 v25, v24
    s_nop 1
    v_permlane16_swap_b32 v24, v25
    v_add_f32 v24, v24, v25
    v_mov_b32 v25, v24
    s_nop 1
    v_permlane32_swap_b32 v24, v25
    v_add_f32 v24, v24, v25
    v_mul_f32 v24, 0x3b124925, v24
    v_mov_b32 v26, 0
    s_mov_b64 exec, s[36:37]
    v_sub_f32 v27, v16, v24
    v_fmac_f32 v26, v27, v27
    v_sub_f32 v27, v17, v24
    v_fmac_f32 v26, v27, v27
    v_sub_f32 v27, v18, v24
    v_fmac_f32 v26, v27, v27
    v_sub_f32 v27, v19, v24
    v_fmac_f32 v26, v27, v27
    v_sub_f32 v27, v20, v24
    v_fmac_f32 v26, v27, v27
    v_sub_f32 v27, v21, v24
    v_fmac_f32 v26, v27, v27
    v_sub_f32 v27, v22, v24
    v_fmac_f32 v26, v27, v27
    v_sub_f32 v27, v23, v24
    v_fmac_f32 v26, v27, v27
    s_mov_b64 exec, -1
    s_nop 0
    v_add_f32_dpp v26, v26, v26 row_ror:8 row_mask:0xf bank_mask:0xf
    s_nop 1
    v_add_f32_dpp v26, v26, v26 row_ror:4 row_mask:0xf bank_mask:0xf
    s_nop 1
    v_add_f32_dpp v26, v26, v26 row_ror:2 row_mask:0xf bank_mask:0xf
    s_nop 1
    v_add_f32_dpp v26, v26, v26 row_ror:1 row_mask:0xf bank_mask:0xf
    v_mov_b32 v25, v26
    s_nop 1
    v_permlane16_swap_b32 v26, v25
    v_add_f32 v26, v26, v25
    v_mov_b32 v25, v26
    s_nop 1
    v_permlane32_swap_b32 v26, v25
    v_add_f32 v26, v26, v25
    v_mul_f32 v26, 0x3b124925, v26
    v_cvt_pk_bf16_f32 v27, v24, v26
    v_lshlrev_b32 v24, 16, v27
    v_and_b32 v26, 0xffff0000, v27
    v_add_f32 v26, 0x3727c5ac, v26
    v_cvt_pk_bf16_f32 v26, v26, v26
    v_and_b32 v26, 0xffff0000, v26
    v_sqrt_f32 v26, v26
    s_nop 0
    v_cvt_pk_bf16_f32 v26, v26, v26
    v_and_b32 v26, 0xffff0000, v26
    v_rcp_f32 v27, v26
    v_sub_f32 v32, v16, v24
    v_sub_f32 v33, v17, v24
    v_cvt_pk_bf16_f32 v32, v32, v33
    v_and_b32 v33, 0xffff0000, v32
    v_lshlrev_b32 v32, 16, v32
    v_mul_f32 v34, v32, v27
    v_mul_f32 v35, v33, v27
    v_fma_f32 v36, -v34, v26, v32
    v_fma_f32 v37, -v35, v26, v33
    v_fmac_f32 v34, v36, v27
    v_fmac_f32 v35, v37, v27
    v_cvt_pk_bf16_f32 v40, v34, v35
    v_sub_f32 v32, v18, v24
    v_sub_f32 v33, v19, v24
    v_cvt_pk_bf16_f32 v32, v32, v33
    v_and_b32 v33, 0xffff0000, v32
    v_lshlrev_b32 v32, 16, v32
    v_mul_f32 v34, v32, v27
    v_mul_f32 v35, v33, v27
    v_fma_f32 v36, -v34, v26, v32
    v_fma_f32 v37, -v35, v26, v33
    v_fmac_f32 v34, v36, v27
    v_fmac_f32 v35, v37, v27
    v_cvt_pk_bf16_f32 v41, v34, v35
    v_sub_f32 v32, v20, v24
    v_sub_f32 v33, v21, v24
    v_cvt_pk_bf16_f32 v32, v32, v33
    v_and_b32 v33, 0xffff0000, v32
    v_lshlrev_b32 v32, 16, v32
    v_mul_f32 v34, v32, v27
    v_mul_f32 v35, v33, v27
    v_fma_f32 v36, -v34, v26, v32
    v_fma_f32 v37, -v35, v26, v33
    v_fmac_f32 v34, v36, v27
    v_fmac_f32 v35, v37, v27
    v_cvt_pk_bf16_f32 v42, v34, v35
    v_sub_f32 v32, v22, v24
    v_sub_f32 v33, v23, v24
    v_cvt_pk_bf16_f32 v32, v32, v33
    v_and_b32 v33, 0xffff0000, v32
    v_lshlrev_b32 v32, 16, v32
    v_mul_f32 v34, v32, v27
    v_mul_f32 v35, v33, v27
    v_fma_f32 v36, -v34, v26, v32
    v_fma_f32 v37, -v35, v26, v33
    v_fmac_f32 v34, v36, v27
    v_fmac_f32 v35, v37, v27
    v_cvt_pk_bf16_f32 v43, v34, v35
    s_mov_b64 exec, s[36:37]
    ds_write_b64 v3, v[40:41]
    ds_write_b64 v3, v[42:43] offset:16
    s_mov_b64 exec, -1
    s_waitcnt lgkmcnt(0)
    s_mov_b64 exec, 1
    v_mov_b32 v16, 1
    ds_add_u32 v15, v16 offset:0
    s_mov_b64 exec, -1
    s_lshl_b32 s34, s4, 16
    s_lshr_b32 s35, s32, 1
    s_lshl_b32 s35, s35, 14
    s_add_u32 s34, s34, s35
    s_lshl_b32 s35, s6, 12
    s_add_u32 s34, s34, s35
    s_lshl_b32 s35, s7, 9
    s_add_u32 s34, s34, s35
    s_and_b32 s35, s32, 1
    s_lshl_b32 s35, s35, 8
    s_add_u32 s34, s34, s35
    s_add_u32 s34, s34, 589824
    v_and_b32 v7, 1, v1
    v_lshlrev_b32 v112, 15, v7
    v_lshl_add_u32 v112, v11, 4, v112
    v_bfe_u32 v7, v1, 1, 2
    v_lshl_add_u32 v112, v7, 6, v112
    v_add_u32 v112, s34, v112
    s_mov_b32 s58, 0x00ff00ff
    s_mov_b32 s59, 0x00ff00ff
    s_lshl_b32 s34, s4, 10
    s_lshl_b32 s35, s6, 7
    s_add_u32 s34, s34, s35
    s_lshl_b32 s35, s7, 4
    s_add_u32 s34, s34, s35
    s_add_u32 s34, s34, 1114112
    v_and_b32 v7, 1, v1
    v_lshlrev_b32 v7, 9, v7
    v_add_u32 v114, s34, v7
    s_mov_b32 s54, 0x11111111
    s_mov_b32 s55, 0x11111111
    v_mov_b32 v116, 0
    v_mov_b32 v117, 0
    v_mov_b32 v118, 0
    v_mov_b32 v119, 0
    s_mov_b64 exec, s[58:59]
    buffer_store_dwordx4 v[116:119], v112, s[92:95], 0 offen
    s_mov_b64 exec, -1
    s_cmp_lg_u32 s32, 0
    s_cbranch_scc1 L_pt_37
    s_mov_b64 exec, 3
    buffer_store_dwordx4 v[116:119], v114, s[92:95], 0 offen
    s_mov_b64 exec, -1
L_pt_37:
    s_lshl_b32 s34, s32, 13
    v_add_u32 v7, 0, v11
    v_xor_b32 v7, v7, v12
    v_lshlrev_b32 v7, 4, v7
    v_lshl_add_u32 v2, v12, 9, v7
    v_add_u32 v2, s34, v2
    v_add_u32 v7, 4, v11
    v_xor_b32 v7, v7, v12
    v_lshlrev_b32 v7, 4, v7
    v_lshl_add_u32 v3, v12, 9, v7
    v_add_u32 v3, s34, v3
    v_add_u32 v7, 8, v11
    v_xor_b32 v7, v7, v12
    v_lshlrev_b32 v7, 4, v7
    v_lshl_add_u32 v4, v12, 9, v7
    v_add_u32 v4, s34, v4
    v_add_u32 v7, 12, v11
    v_xor_b32 v7, v7, v12
    v_lshlrev_b32 v7, 4, v7
    v_lshl_add_u32 v5, v12, 9, v7
    v_add_u32 v5, s34, v5
    s_add_u32 s46, s32, 1
    s_lshl_b32 s47, s32, 2
    v_mov_b32 v9, s47
    v_add_u32 v9, 163712, v9
    s_mov_b32 s98, 262144
L_w_38:
    ds_read_b32 v8, v15 offset:12
    s_sub_u32 s98, s98, 1
    s_cbranch_scc1 L_wd_39
    s_waitcnt lgkmcnt(0)
    v_readfirstlane_b32 s99, v8
    s_cmp_ge_u32 s99, s46
    s_cbranch_scc1 L_wd_39
    s_sleep 1
    s_branch L_w_38
L_wd_39:
    s_waitcnt lgkmcnt(0)
    ds_read_b128 v[128:131], v2 offset:0
    ds_read_b128 v[132:135], v3 offset:0
    ds_read_b128 v[136:139], v4 offset:0
    ds_read_b128 v[140:143], v5 offset:0
    ds_read_b128 v[144:147], v2 offset:256
    ds_read_b128 v[148:151], v3 offset:256
    ds_read_b128 v[152:155], v4 offset:256
    ds_read_b128 v[156:159], v5 offset:256
    s_waitcnt lgkmcnt(0)
    s_mov_b64 exec, 1
    v_mov_b32 v8, 1
    ds_write_b32 v9, v8 offset:32
    s_mov_b64 exec, -1
    v_add_u32 v20, 0x10000, v2
    v_add_u32 v21, 0x10000, v3
    v_add_u32 v22, 0x10000, v4
    v_add_u32 v23, 0x10000, v5
    s_add_u32 s46, s46, 4
    s_mov_b32 s98, 262144
L_w_40:
    ds_read_b32 v8, v15 offset:12
    s_sub_u32 s98, s98, 1
    s_cbranch_scc1 L_wd_41
    s_waitcnt lgkmcnt(0)
    v_readfirstlane_b32 s99, v8
    s_cmp_ge_u32 s99, s46
    s_cbranch_scc1 L_wd_41
    s_sleep 1
    s_branch L_w_40
L_wd_41:
    s_waitcnt lgkmcnt(0)
    ds_read_b128 v[160:163], v2 offset:32768
    ds_read_b128 v[164:167], v3 offset:32768
    ds_read_b128 v[168:171], v4 offset:32768
    ds_read_b128 v[172:175], v5 offset:32768
    ds_read_b128 v[176:179], v2 offset:33024
    ds_read_b128 v[180:183], v3 offset:33024
    ds_read_b128 v[184:187], v4 offset:33024
    ds_read_b128 v[188:191], v5 offset:33024
    s_waitcnt lgkmcnt(0)
    s_mov_b64 exec, 1
    v_mov_b32 v8, 2
    ds_write_b32 v9, v8 offset:32
    s_mov_b64 exec, -1
    s_add_u32 s46, s46, 4
    s_mov_b32 s98, 262144
L_w_42:
    ds_read_b32 v8, v15 offset:12
    s_sub_u32 s98, s98, 1
    s_cbranch_scc1 L_wd_43
    s_waitcnt lgkmcnt(0)
    v_readfirstlane_b32 s99, v8
    s_cmp_ge_u32 s99, s46
    s_cbranch_scc1 L_wd_43
    s_sleep 1
    s_branch L_w_42
L_wd_43:
    s_waitcnt lgkmcnt(0)
    ds_read_b128 v[192:195], v20 offset:0
    ds_read_b128 v[196:199], v21 offset:0
    ds_read_b128 v[200:203], v22 offset:0
    ds_read_b128 v[204:207], v23 offset:0
    ds_read_b128 v[208:211], v20 offset:256
    ds_read_b128 v[212:215], v21 offset:256
    ds_read_b128 v[216:219], v22 offset:256
    ds_read_b128 v[220:223], v23 offset:256
    s_waitcnt lgkmcnt(0)
    s_mov_b64 exec, 1
    v_mov_b32 v8, 3
    ds_write_b32 v9, v8 offset:32
    s_mov_b64 exec, -1
    s_add_u32 s46, s46, 4
    s_mov_b32 s98, 262144
L_w_44:
    ds_read_b32 v8, v15 offset:12
    s_sub_u32 s98, s98, 1
    s_cbranch_scc1 L_wd_45
    s_waitcnt lgkmcnt(0)
    v_readfirstlane_b32 s99, v8
    s_cmp_ge_u32 s99, s46
    s_cbranch_scc1 L_wd_45
    s_sleep 1
    s_branch L_w_44
L_wd_45:
    s_waitcnt lgkmcnt(0)
    ds_read_b128 v[224:227], v2 offset:0
    ds_read_b128 v[228:231], v3 offset:0
    ds_read_b128 v[232:235], v4 offset:0
    ds_read_b128 v[236:239], v5 offset:0
    ds_read_b128 v[240:243], v2 offset:256
    ds_read_b128 v[244:247], v3 offset:256
    ds_read_b128 v[248:251], v4 offset:256
    ds_read_b128 v[252:255], v5 offset:256
    s_waitcnt lgkmcnt(0)
    s_mov_b64 exec, 1
    v_mov_b32 v8, 4
    ds_write_b32 v9, v8 offset:32
    s_mov_b64 exec, -1
    v_lshlrev_b32 v13, 7, v11
    v_lshrrev_b32 v7, 2, v12
    v_lshl_add_u32 v13, v7, 4, v13
    v_and_b32 v7, 3, v12
    v_lshl_add_u32 v13, v7, 1, v13
    s_lshr_b32 s34, s32, 1
    s_lshl_b32 s34, s34, 6
    s_and_b32 s35, s32, 1
    s_lshl_b32 s35, s35, 3
    s_add_u32 s34, s34, s35
    s_add_u32 s34, s34, 161024
    v_add_u32 v13, s34, v13
    s_mov_b32 s98, 262144
L_w_46:
    ds_read_b32 v16, v15 offset:24
    s_sub_u32 s98, s98, 1
    s_cbranch_scc1 L_wd_47
    s_waitcnt lgkmcnt(0)
    v_readfirstlane_b32 s99, v16
    s_cmp_ge_u32 s99, 1
    s_cbranch_scc1 L_wd_47
    s_sleep 1
    s_branch L_w_46
L_wd_47:
    s_waitcnt lgkmcnt(0)
    ds_read_b64 v[16:17], v15 offset:64
    v_and_b32 v4, 1, v1
    v_lshlrev_b32 v4, 9, v4
    v_lshl_add_u32 v4, v11, 4, v4
    v_add_u32 v4, 160000, v4
    ds_read_b128 v[64:67], v4 offset:0
    ds_read_b128 v[68:71], v4 offset:64
    ds_read_b128 v[72:75], v4 offset:128
    ds_read_b128 v[76:79], v4 offset:192
    ds_read_b128 v[80:83], v4 offset:256
    ds_read_b128 v[84:87], v4 offset:320
    ds_read_b128 v[88:91], v4 offset:384
    ds_read_b128 v[92:95], v4 offset:448
    s_waitcnt lgkmcnt(8)
    v_mov_b32 v14, v16
    v_readfirstlane_b32 s78, v17
    s_sub_u32 s78, s78, 1
    s_waitcnt lgkmcnt(7)
    v_mfma_f32_16x16x32_bf16 v[16:19], v[64:67], v[128:131], 0
    v_mfma_f32_16x16x32_bf16 v[20:23], v[64:67], v[160:163], 0
    v_mfma_f32_16x16x32_bf16 v[24:27], v[64:67], v[192:195], 0
    v_mfma_f32_16x16x32_bf16 v[28:31], v[64:67], v[224:227], 0
    s_waitcnt lgkmcnt(6)
    v_mfma_f32_16x16x32_bf16 v[16:19], v[68:71], v[132:135], v[16:19]
    v_mfma_f32_16x16x32_bf16 v[20:23], v[68:71], v[164:167], v[20:23]
    v_mfma_f32_16x16x32_bf16 v[24:27], v[68:71], v[196:199], v[24:27]
    v_mfma_f32_16x16x32_bf16 v[28:31], v[68:71], v[228:231], v[28:31]
    s_waitcnt lgkmcnt(5)
    v_mfma_f32_16x16x32_bf16 v[16:19], v[72:75], v[136:139], v[16:19]
    v_mfma_f32_16x16x32_bf16 v[20:23], v[72:75], v[168:171], v[20:23]
    v_mfma_f32_16x16x32_bf16 v[24:27], v[72:75], v[200:203], v[24:27]
    v_mfma_f32_16x16x32_bf16 v[28:31], v[72:75], v[232:235], v[28:31]
    s_waitcnt lgkmcnt(4)
    v_mfma_f32_16x16x32_bf16 v[16:19], v[76:79], v[140:143], v[16:19]
    v_mfma_f32_16x16x32_bf16 v[20:23], v[76:79], v[172:175], v[20:23]
    v_mfma_f32_16x16x32_bf16 v[24:27], v[76:79], v[204:207], v[24:27]
    v_mfma_f32_16x16x32_bf16 v[28:31], v[76:79], v[236:239], v[28:31]
    s_waitcnt lgkmcnt(3)
    v_mfma_f32_16x16x32_bf16 v[16:19], v[80:83], v[144:147], v[16:19]
    v_mfma_f32_16x16x32_bf16 v[20:23], v[80:83], v[176:179], v[20:23]
    v_mfma_f32_16x16x32_bf16 v[24:27], v[80:83], v[208:211], v[24:27]
    v_mfma_f32_16x16x32_bf16 v[28:31], v[80:83], v[240:243], v[28:31]
    s_waitcnt lgkmcnt(2)
    v_mfma_f32_16x16x32_bf16 v[16:19], v[84:87], v[148:151], v[16:19]
    v_mfma_f32_16x16x32_bf16 v[20:23], v[84:87], v[180:183], v[20:23]
    v_mfma_f32_16x16x32_bf16 v[24:27], v[84:87], v[212:215], v[24:27]
    v_mfma_f32_16x16x32_bf16 v[28:31], v[84:87], v[244:247], v[28:31]
    s_waitcnt lgkmcnt(1)
    v_mfma_f32_16x16x32_bf16 v[16:19], v[88:91], v[152:155], v[16:19]
    v_mfma_f32_16x16x32_bf16 v[20:23], v[88:91], v[184:187], v[20:23]
    v_mfma_f32_16x16x32_bf16 v[24:27], v[88:91], v[216:219], v[24:27]
    v_mfma_f32_16x16x32_bf16 v[28:31], v[88:91], v[248:251], v[28:31]
    s_waitcnt lgkmcnt(0)
    v_mfma_f32_16x16x32_bf16 v[16:19], v[92:95], v[156:159], v[16:19]
    v_mfma_f32_16x16x32_bf16 v[20:23], v[92:95], v[188:191], v[20:23]
    v_mfma_f32_16x16x32_bf16 v[24:27], v[92:95], v[220:223], v[24:27]
    v_mfma_f32_16x16x32_bf16 v[28:31], v[92:95], v[252:255], v[28:31]
    s_nop 5
    v_mov_b32_dpp v16, v20 quad_perm:[0,1,2,3] row_mask:0x2 bank_mask:0xf
    s_nop 1
    v_mov_b32_dpp v16, v24 quad_perm:[0,1,2,3] row_mask:0x4 bank_mask:0xf
    s_nop 1
    v_mov_b32_dpp v16, v28 quad_perm:[0,1,2,3] row_mask:0x8 bank_mask:0xf
    v_mov_b32_dpp v17, v21 quad_perm:[0,1,2,3] row_mask:0x2 bank_mask:0xf
    s_nop 1
    v_mov_b32_dpp v17, v25 quad_perm:[0,1,2,3] row_mask:0x4 bank_mask:0xf
    s_nop 1
    v_mov_b32_dpp v17, v29 quad_perm:[0,1,2,3] row_mask:0x8 bank_mask:0xf
    v_cvt_pk_bf16_f32 v20, v16, v17
    v_lshlrev_b32 v16, 16, v20
    v_and_b32 v17, 0xffff0000, v20
    v_max_f32 v32, 0xff7fffff, v16
    v_max_f32 v33, 0xff7fffff, v17
    s_nop 0
    v_max_f32_dpp v32, v32, v32 row_ror:8 row_mask:0xf bank_mask:0xf
    v_max_f32_dpp v33, v33, v33 row_ror:8 row_mask:0xf bank_mask:0xf
    s_nop 0
    v_max_f32_dpp v32, v32, v32 row_ror:4 row_mask:0xf bank_mask:0xf
    v_max_f32_dpp v33, v33, v33 row_ror:4 row_mask:0xf bank_mask:0xf
    s_nop 0
    v_max_f32_dpp v32, v32, v32 row_ror:2 row_mask:0xf bank_mask:0xf
    v_max_f32_dpp v33, v33, v33 row_ror:2 row_mask:0xf bank_mask:0xf
    s_nop 0
    v_max_f32_dpp v32, v32, v32 row_ror:1 row_mask:0xf bank_mask:0xf
    v_max_f32_dpp v33, v33, v33 row_ror:1 row_mask:0xf bank_mask:0xf
    v_mov_b32 v36, v32
    v_mov_b32 v37, v33
    s_nop 0
    v_permlane16_swap_b32 v32, v36
    v_permlane16_swap_b32 v33, v37
    v_max_f32 v32, v32, v36
    v_max_f32 v33, v33, v37
    v_mov_b32 v36, v32
    v_mov_b32 v37, v33
    s_nop 0
    v_permlane32_swap_b32 v32, v36
    v_permlane32_swap_b32 v33, v37
    v_max_f32 v32, v32, v36
    v_max_f32 v33, v33, v37
    s_mov_b32 s50, 0x3db8aa3b
    v_sub_f32 v16, v16, v32
    v_sub_f32 v17, v17, v33
    v_mul_f32 v16, s50, v16
    v_mul_f32 v17, s50, v17
    v_exp_f32 v16, v16
    v_exp_f32 v17, v17
    v_mov_b32 v34, v16
    v_mov_b32 v35, v17
    s_nop 0
    v_add_f32_dpp v34, v34, v34 row_ror:8 row_mask:0xf bank_mask:0xf
    v_add_f32_dpp v35, v35, v35 row_ror:8 row_mask:0xf bank_mask:0xf
    s_nop 0
    v_add_f32_dpp v34, v34, v34 row_ror:4 row_mask:0xf bank_mask:0xf
    v_add_f32_dpp v35, v35, v35 row_ror:4 row_mask:0xf bank_mask:0xf
    s_nop 0
    v_add_f32_dpp v34, v34, v34 row_ror:2 row_mask:0xf bank_mask:0xf
    v_add_f32_dpp v35, v35, v35 row_ror:2 row_mask:0xf bank_mask:0xf
    s_nop 0
    v_add_f32_dpp v34, v34, v34 row_ror:1 row_mask:0xf bank_mask:0xf
    v_add_f32_dpp v35, v35, v35 row_ror:1 row_mask:0xf bank_mask:0xf
    v_mov_b32 v36, v34
    v_mov_b32 v37, v35
    s_nop 0
    v_permlane16_swap_b32 v34, v36
    v_permlane16_swap_b32 v35, v37
    v_add_f32 v34, v34, v36
    v_add_f32 v35, v35, v37
    v_mov_b32 v36, v34
    v_mov_b32 v37, v35
    s_nop 0
    v_permlane32_swap_b32 v34, v36
    v_permlane32_swap_b32 v35, v37
    v_add_f32 v34, v34, v36
    v_add_f32 v35, v35, v37
    s_lshl_b32 s34, s32, 4
    s_add_u32 s34, s34, 162112
    v_mov_b32 v36, s34
    s_mov_b64 exec, 1
    ds_write_b128 v36, v[32:35]
    s_mov_b64 exec, -1
    s_waitcnt lgkmcnt(0)
    s_mov_b64 exec, 1
    v_mov_b32 v37, 1
    ds_add_u32 v15, v37 offset:48
    s_mov_b64 exec, -1
    v_lshrrev_b32 v2, 2, v1
    v_bfe_u32 v3, v1, 2, 3
    s_lshl_b32 s34, s32, 2
    s_add_u32 s35, s34, 0
    v_xor_b32 v4, s35, v3
    v_lshlrev_b32 v4, 5, v4
    v_lshl_add_u32 v40, v2, 9, v4
    v_and_b32 v4, 3, v1
    v_lshl_add_u32 v40, v4, 3, v40
    v_add_u32 v44, 0x10000, v40
    s_add_u32 s35, s34, 1
    v_xor_b32 v4, s35, v3
    v_lshlrev_b32 v4, 5, v4
    v_lshl_add_u32 v41, v2, 9, v4
    v_and_b32 v4, 3, v1
    v_lshl_add_u32 v41, v4, 3, v41
    v_add_u32 v45, 0x10000, v41
    s_add_u32 s35, s34, 2
    v_xor_b32 v4, s35, v3
    v_lshlrev_b32 v4, 5, v4
    v_lshl_add_u32 v42, v2, 9, v4
    v_and_b32 v4, 3, v1
    v_lshl_add_u32 v42, v4, 3, v42
    v_add_u32 v46, 0x10000, v42
    s_add_u32 s35, s34, 3
    v_xor_b32 v4, s35, v3
    v_lshlrev_b32 v4, 5, v4
    v_lshl_add_u32 v43, v2, 9, v4
    v_and_b32 v4, 3, v1
    v_lshl_add_u32 v43, v4, 3, v43
    v_add_u32 v47, 0x10000, v43
    v_and_b32 v2, 1, v1
    v_mul_u32_u24 v8, 544, v2
    v_lshl_add_u32 v8, v11, 4, v8
    v_add_u32 v8, 161024, v8
    s_mov_b32 s98, 262144
L_w_48:
    ds_read_b32 v37, v15 offset:48
    s_sub_u32 s98, s98, 1
    s_cbranch_scc1 L_wd_49
    s_waitcnt lgkmcnt(0)
    v_readfirstlane_b32 s99, v37
    s_cmp_ge_u32 s99, 4
    s_cbranch_scc0 L_w_48
L_wd_49:
    s_waitcnt lgkmcnt(0)
    v_mov_b32 v36, 162112
    ds_read_b128 v[48:51], v36 offset:0
    ds_read_b128 v[52:55], v36 offset:16
    ds_read_b128 v[56:59], v36 offset:32
    ds_read_b128 v[60:63], v36 offset:48
    s_waitcnt lgkmcnt(0)
    v_max3_f32 v28, v48, v52, v56
    v_max_f32 v28, v28, v60
    v_max3_f32 v29, v49, v53, v57
    v_max_f32 v29, v29, v61
    v_sub_f32 v48, v48, v28
    v_sub_f32 v49, v49, v29
    v_sub_f32 v52, v52, v28
    v_sub_f32 v53, v53, v29
    v_sub_f32 v56, v56, v28
    v_sub_f32 v57, v57, v29
    v_sub_f32 v60, v60, v28
    v_sub_f32 v61, v61, v29
    v_sub_f32 v32, v32, v28
    v_sub_f32 v33, v33, v29
    v_mul_f32 v48, s50, v48
    v_mul_f32 v49, s50, v49
    v_mul_f32 v52, s50, v52
    v_mul_f32 v53, s50, v53
    v_mul_f32 v56, s50, v56
    v_mul_f32 v57, s50, v57
    v_mul_f32 v60, s50, v60
    v_mul_f32 v61, s50, v61
    v_mul_f32 v32, s50, v32
    v_mul_f32 v33, s50, v33
    v_exp_f32 v48, v48
    v_exp_f32 v49, v49
    v_exp_f32 v52, v52
    v_exp_f32 v53, v53
    v_exp_f32 v56, v56
    v_exp_f32 v57, v57
    v_exp_f32 v60, v60
    v_exp_f32 v61, v61
    v_exp_f32 v32, v32
    v_exp_f32 v33, v33
    v_mul_f32 v30, v48, v50
    v_mul_f32 v31, v49, v51
    v_fmac_f32 v30, v52, v54
    v_fmac_f32 v31, v53, v55
    v_fmac_f32 v30, v56, v58
    v_fmac_f32 v31, v57, v59
    v_fmac_f32 v30, v60, v62
    v_fmac_f32 v31, v61, v63
    v_mul_f32 v16, v16, v32
    v_mul_f32 v17, v17, v33
    v_cvt_pk_bf16_f32 v20, v16, v17
    ds_write_b16 v13, v20
    ds_write_b16_d16_hi v13, v20 offset:544
    s_waitcnt lgkmcnt(0)
    s_mov_b64 exec, 1
    v_mov_b32 v37, 1
    ds_add_u32 v15, v37 offset:52
    s_mov_b64 exec, -1
    s_cmp_lg_u32 s32, 0
    s_cbranch_scc1 L_nst_50
    v_and_b32 v2, 1, v1
    v_cmp_eq_u32 vcc, 1, v2
    s_nop 1
    v_cndmask_b32 v32, v28, v29, vcc
    v_cndmask_b32 v33, v30, v31, vcc
    v_mov_b32 v34, 0
    v_mov_b32 v35, 0
    v_perm_b32 v32, v32, v14, s72
    v_perm_b32 v33, v33, v14, s73
    v_perm_b32 v34, v34, v14, s74
    v_perm_b32 v35, v35, v14, s75
    s_mov_b64 exec, 3
    s_cmp_lg_u32 s78, 0
    s_cbranch_scc1 L_sm_51
    buffer_store_dwordx4 v[32:35], v114, s[92:95], 0 offen
    s_branch L_sme_52
L_sm_51:
    buffer_store_dwordx4 v[32:35], v114, s[92:95], 0 offen sc1
L_sme_52:
    s_mov_b64 exec, -1
L_nst_50:
    s_min_u32 s34, s5, 27
    s_mul_i32 s56, s34, 37
    s_lshr_b32 s56, s56, 8
    s_mul_i32 s57, s56, 7
    s_sub_u32 s57, s34, s57
    s_lshl_b32 s34, s4, 16
    s_lshl_b32 s35, s56, 14
    s_add_u32 s34, s34, s35
    s_lshl_b32 s35, s32, 12
    s_add_u32 s34, s34, s35
    s_add_u32 s34, s34, 589824
    v_lshlrev_b32 v120, 4, v1
    v_add_u32 v120, s34, v120
    s_lshl_b32 s34, s4, 10
    s_lshr_b32 s35, s56, 1
    s_lshl_b32 s35, s35, 9
    s_add_u32 s34, s34, s35
    s_lshl_b32 s35, s32, 7
    s_add_u32 s34, s34, s35
    s_add_u32 s34, s34, 1114112
    v_and_b32 v124, 7, v1
    v_lshlrev_b32 v124, 4, v124
    v_add_u32 v124, s34, v124
    v_bfe_u32 v121, v1, 3, 2
    v_lshlrev_b32 v121, 6, v121
    v_and_b32 v5, 3, v1
    v_lshl_add_u32 v121, v5, 4, v121
    v_bfe_u32 v5, v1, 2, 1
    v_lshl_add_u32 v121, v5, 3, v121
    s_mul_i32 s34, s32, 272
    s_add_u32 s34, s34, 162624
    v_add_u32 v121, s34, v121
    v_and_b32 v122, 3, v1
    v_mul_u32_u24 v122, 272, v122
    v_lshl_add_u32 v122, v11, 4, v122
    v_add_u32 v122, 162624, v122
    s_lshl_b32 s34, s4, 2
    s_add_u32 s34, s34, s56
    s_lshl_b32 s34, s34, 8
    s_lshl_b32 s35, s57, 13
    s_add_u32 s34, s34, s35
    s_lshl_b32 s35, s32, 6
    s_add_u32 s34, s34, s35
    s_add_u32 s34, s34, 1441792
    v_and_b32 v5, 3, v1
    v_mul_u32_u24 v123, 7168, v5
    v_lshlrev_b32 v123, 3, v123
    v_lshl_add_u32 v123, v11, 4, v123
    v_add_u32 v123, s34, v123
    s_mov_b32 s98, 262144
L_w_53:
    ds_read_b32 v37, v15 offset:52
    s_sub_u32 s98, s98, 1
    s_cbranch_scc1 L_wd_54
    s_waitcnt lgkmcnt(0)
    v_readfirstlane_b32 s99, v37
    s_cmp_ge_u32 s99, 4
    s_cbranch_scc0 L_w_53
L_wd_54:
    s_waitcnt lgkmcnt(0)
    s_mov_b32 s52, 0
    s_cmp_ge_u32 s52, 2
    s_cbranch_scc1 L_lv_55
    s_mov_b32 s98, 262144
L_w_56:
    ds_read_b32 v2, v15 offset:20
    s_sub_u32 s98, s98, 1
    s_cbranch_scc1 L_wd_57
    s_waitcnt lgkmcnt(0)
    v_readfirstlane_b32 s99, v2
    s_cmp_ge_u32 s99, 2
    s_cbranch_scc0 L_w_56
L_wd_57:
    s_waitcnt lgkmcnt(0)
    s_mov_b32 s52, s99
L_lv_55:
    ds_read_b64_tr_b16 v[48:49], v40 offset:32768
    ds_read_b64_tr_b16 v[52:53], v41 offset:32768
    ds_read_b64_tr_b16 v[56:57], v42 offset:32768
    ds_read_b64_tr_b16 v[60:61], v43 offset:32768
    ds_read_b64_tr_b16 v[50:51], v40 offset:40960
    ds_read_b64_tr_b16 v[54:55], v41 offset:40960
    ds_read_b64_tr_b16 v[58:59], v42 offset:40960
    ds_read_b64_tr_b16 v[62:63], v43 offset:40960
    ds_read_b128 v[64:67], v8 offset:0
    s_cmp_ge_u32 s52, 4
    s_cbranch_scc1 L_lv_58
    s_mov_b32 s98, 262144
L_w_59:
    ds_read_b32 v2, v15 offset:20
    s_sub_u32 s98, s98, 1
    s_cbranch_scc1 L_wd_60
    s_waitcnt lgkmcnt(0)
    v_readfirstlane_b32 s99, v2
    s_cmp_ge_u32 s99, 4
    s_cbranch_scc0 L_w_59
L_wd_60:
    s_waitcnt lgkmcnt(0)
    s_mov_b32 s52, s99
L_lv_58:
    ds_read_b64_tr_b16 v[68:69], v40 offset:49152
    ds_read_b64_tr_b16 v[72:73], v41 offset:49152
    ds_read_b64_tr_b16 v[76:77], v42 offset:49152
    ds_read_b64_tr_b16 v[80:81], v43 offset:49152
    ds_read_b64_tr_b16 v[70:71], v40 offset:57344
    ds_read_b64_tr_b16 v[74:75], v41 offset:57344
    ds_read_b64_tr_b16 v[78:79], v42 offset:57344
    ds_read_b64_tr_b16 v[82:83], v43 offset:57344
    ds_read_b128 v[84:87], v8 offset:64
    s_waitcnt lgkmcnt(9)
    v_mfma_f32_16x16x32_bf16 v[16:19], v[48:51], v[64:67], 0
    v_mfma_f32_16x16x32_bf16 v[20:23], v[52:55], v[64:67], 0
    v_mfma_f32_16x16x32_bf16 v[24:27], v[56:59], v[64:67], 0
    v_mfma_f32_16x16x32_bf16 v[28:31], v[60:63], v[64:67], 0
    s_cmp_ge_u32 s52, 6
    s_cbranch_scc1 L_lv_61
    s_mov_b32 s98, 262144
L_w_62:
    ds_read_b32 v2, v15 offset:20
    s_sub_u32 s98, s98, 1
    s_cbranch_scc1 L_wd_63
    s_waitcnt lgkmcnt(0)
    v_readfirstlane_b32 s99, v2
    s_cmp_ge_u32 s99, 6
    s_cbranch_scc0 L_w_62
L_wd_63:
    s_waitcnt lgkmcnt(0)
    s_mov_b32 s52, s99
L_lv_61:
    ds_read_b64_tr_b16 v[48:49], v44 offset:0
    ds_read_b64_tr_b16 v[52:53], v45 offset:0
    ds_read_b64_tr_b16 v[56:57], v46 offset:0
    ds_read_b64_tr_b16 v[60:61], v47 offset:0
    ds_read_b64_tr_b16 v[50:51], v44 offset:8192
    ds_read_b64_tr_b16 v[54:55], v45 offset:8192
    ds_read_b64_tr_b16 v[58:59], v46 offset:8192
    ds_read_b64_tr_b16 v[62:63], v47 offset:8192
    ds_read_b128 v[64:67], v8 offset:128
    s_waitcnt lgkmcnt(9)
    v_mfma_f32_16x16x32_bf16 v[16:19], v[68:71], v[84:87], v[16:19]
    v_mfma_f32_16x16x32_bf16 v[20:23], v[72:75], v[84:87], v[20:23]
    v_mfma_f32_16x16x32_bf16 v[24:27], v[76:79], v[84:87], v[24:27]
    v_mfma_f32_16x16x32_bf16 v[28:31], v[80:83], v[84:87], v[28:31]
    s_cmp_ge_u32 s52, 8
    s_cbranch_scc1 L_lv_64
    s_mov_b32 s98, 262144
L_w_65:
    ds_read_b32 v2, v15 offset:20
    s_sub_u32 s98, s98, 1
    s_cbranch_scc1 L_wd_66
    s_waitcnt lgkmcnt(0)
    v_readfirstlane_b32 s99, v2
    s_cmp_ge_u32 s99, 8
    s_cbranch_scc0 L_w_65
L_wd_66:
    s_waitcnt lgkmcnt(0)
    s_mov_b32 s52, s99
L_lv_64:
    ds_read_b64_tr_b16 v[68:69], v44 offset:16384
    ds_read_b64_tr_b16 v[72:73], v45 offset:16384
    ds_read_b64_tr_b16 v[76:77], v46 offset:16384
    ds_read_b64_tr_b16 v[80:81], v47 offset:16384
    ds_read_b64_tr_b16 v[70:71], v44 offset:24576
    ds_read_b64_tr_b16 v[74:75], v45 offset:24576
    ds_read_b64_tr_b16 v[78:79], v46 offset:24576
    ds_read_b64_tr_b16 v[82:83], v47 offset:24576
    ds_read_b128 v[84:87], v8 offset:192
    s_waitcnt lgkmcnt(9)
    v_mfma_f32_16x16x32_bf16 v[16:19], v[48:51], v[64:67], v[16:19]
    v_mfma_f32_16x16x32_bf16 v[20:23], v[52:55], v[64:67], v[20:23]
    v_mfma_f32_16x16x32_bf16 v[24:27], v[56:59], v[64:67], v[24:27]
    v_mfma_f32_16x16x32_bf16 v[28:31], v[60:63], v[64:67], v[28:31]
    buffer_load_dwordx4 v[116:119], v124, s[92:95], 0 offen
    s_cmp_ge_u32 s52, 10
    s_cbranch_scc1 L_lv_67
    s_mov_b32 s98, 262144
L_w_68:
    ds_read_b32 v2, v15 offset:20
    s_sub_u32 s98, s98, 1
    s_cbranch_scc1 L_wd_69
    s_waitcnt lgkmcnt(0)
    v_readfirstlane_b32 s99, v2
    s_cmp_ge_u32 s99, 10
    s_cbranch_scc0 L_w_68
L_wd_69:
    s_waitcnt lgkmcnt(0)
    s_mov_b32 s52, s99
L_lv_67:
    ds_read_b64_tr_b16 v[48:49], v40 offset:0
    ds_read_b64_tr_b16 v[52:53], v41 offset:0
    ds_read_b64_tr_b16 v[56:57], v42 offset:0
    ds_read_b64_tr_b16 v[60:61], v43 offset:0
    ds_read_b64_tr_b16 v[50:51], v40 offset:8192
    ds_read_b64_tr_b16 v[54:55], v41 offset:8192
    ds_read_b64_tr_b16 v[58:59], v42 offset:8192
    ds_read_b64_tr_b16 v[62:63], v43 offset:8192
    ds_read_b128 v[64:67], v8 offset:256
    s_waitcnt lgkmcnt(9)
    v_mfma_f32_16x16x32_bf16 v[16:19], v[68:71], v[84:87], v[16:19]
    v_mfma_f32_16x16x32_bf16 v[20:23], v[72:75], v[84:87], v[20:23]
    v_mfma_f32_16x16x32_bf16 v[24:27], v[76:79], v[84:87], v[24:27]
    v_mfma_f32_16x16x32_bf16 v[28:31], v[80:83], v[84:87], v[28:31]
    s_cmp_ge_u32 s52, 12
    s_cbranch_scc1 L_lv_70
    s_mov_b32 s98, 262144
L_w_71:
    ds_read_b32 v2, v15 offset:20
    s_sub_u32 s98, s98, 1
    s_cbranch_scc1 L_wd_72
    s_waitcnt lgkmcnt(0)
    v_readfirstlane_b32 s99, v2
    s_cmp_ge_u32 s99, 12
    s_cbranch_scc0 L_w_71
L_wd_72:
    s_waitcnt lgkmcnt(0)
    s_mov_b32 s52, s99
L_lv_70:
    ds_read_b64_tr_b16 v[68:69], v40 offset:16384
    ds_read_b64_tr_b16 v[72:73], v41 offset:16384
    ds_read_b64_tr_b16 v[76:77], v42 offset:16384
    ds_read_b64_tr_b16 v[80:81], v43 offset:16384
    ds_read_b64_tr_b16 v[70:71], v40 offset:24576
    ds_read_b64_tr_b16 v[74:75], v41 offset:24576
    ds_read_b64_tr_b16 v[78:79], v42 offset:24576
    ds_read_b64_tr_b16 v[82:83], v43 offset:24576
    ds_read_b128 v[84:87], v8 offset:320
    s_waitcnt lgkmcnt(9)
    v_mfma_f32_16x16x32_bf16 v[16:19], v[48:51], v[64:67], v[16:19]
    v_mfma_f32_16x16x32_bf16 v[20:23], v[52:55], v[64:67], v[20:23]
    v_mfma_f32_16x16x32_bf16 v[24:27], v[56:59], v[64:67], v[24:27]
    v_mfma_f32_16x16x32_bf16 v[28:31], v[60:63], v[64:67], v[28:31]
    v_bfe_u32 v4, v1, 3, 2
    v_xor_b32 v4, s32, v4
    v_lshlrev_b32 v4, 5, v4
    v_lshrrev_b32 v115, 2, v1
    v_lshl_add_u32 v115, v115, 7, v4
    v_and_b32 v4, 3, v1
    v_lshl_add_u32 v115, v4, 3, v115
    v_add_u32 v115, 131072, v115
    s_cmp_ge_u32 s52, 14
    s_cbranch_scc1 L_lv_73
    s_mov_b32 s98, 262144
L_w_74:
    ds_read_b32 v2, v15 offset:20
    s_sub_u32 s98, s98, 1
    s_cbranch_scc1 L_wd_75
    s_waitcnt lgkmcnt(0)
    v_readfirstlane_b32 s99, v2
    s_cmp_ge_u32 s99, 14
    s_cbranch_scc0 L_w_74
L_wd_75:
    s_waitcnt lgkmcnt(0)
    s_mov_b32 s52, s99
L_lv_73:
    ds_read_b64_tr_b16 v[48:49], v44 offset:32768
    ds_read_b64_tr_b16 v[52:53], v45 offset:32768
    ds_read_b64_tr_b16 v[56:57], v46 offset:32768
    ds_read_b64_tr_b16 v[60:61], v47 offset:32768
    ds_read_b64_tr_b16 v[50:51], v44 offset:40960
    ds_read_b64_tr_b16 v[54:55], v45 offset:40960
    ds_read_b64_tr_b16 v[58:59], v46 offset:40960
    ds_read_b64_tr_b16 v[62:63], v47 offset:40960
    ds_read_b128 v[64:67], v8 offset:384
    s_waitcnt lgkmcnt(9)
    v_mfma_f32_16x16x32_bf16 v[16:19], v[68:71], v[84:87], v[16:19]
    v_mfma_f32_16x16x32_bf16 v[20:23], v[72:75], v[84:87], v[20:23]
    v_mfma_f32_16x16x32_bf16 v[24:27], v[76:79], v[84:87], v[24:27]
    v_mfma_f32_16x16x32_bf16 v[28:31], v[80:83], v[84:87], v[28:31]
    s_waitcnt vmcnt(0)
    v_perm_b32 v126, v117, v116, s76
    v_perm_b32 v127, v119, v118, s77
    v_or_b32 v126, v126, v127
    v_cmp_eq_u32 s[40:41], v14, v126
    s_cmp_eq_u64 s[40:41], -1
    s_cbranch_scc1 L_stok_76
    s_mov_b32 s98, 16384
L_stg_77:
    buffer_load_dwordx4 v[116:119], v124, s[92:95], 0 offen sc1
L_stgc_79:
    s_sub_u32 s98, s98, 1
    s_cbranch_scc1 L_stgd_78
    s_waitcnt vmcnt(0)
    v_perm_b32 v126, v117, v116, s76
    v_perm_b32 v127, v119, v118, s77
    v_or_b32 v126, v126, v127
    v_cmp_eq_u32 s[40:41], v14, v126
    s_cmp_eq_u64 s[40:41], -1
    s_cbranch_scc1 L_stgd_78
    s_sleep 2
    s_branch L_stg_77
L_stgd_78:
    s_waitcnt vmcnt(0)
L_stok_76:
    v_and_b32 v116, 0xffffff00, v116
    v_and_b32 v117, 0xffffff00, v117
    v_mov_b32 v118, v116
    s_nop 1
    v_max_f32_dpp v118, v118, v118 row_ror:1 row_mask:0xf bank_mask:0xf
    s_nop 1
    v_max_f32_dpp v118, v118, v118 row_ror:2 row_mask:0xf bank_mask:0xf
    s_nop 1
    v_max_f32_dpp v118, v118, v118 row_ror:4 row_mask:0xf bank_mask:0xf
    v_sub_f32 v116, v116, v118
    v_mul_f32 v116, s50, v116
    v_exp_f32 v116, v116
    s_nop 0
    v_mul_f32 v119, v116, v117
    s_nop 1
    v_add_f32_dpp v119, v119, v119 row_ror:1 row_mask:0xf bank_mask:0xf
    s_nop 1
    v_add_f32_dpp v119, v119, v119 row_ror:2 row_mask:0xf bank_mask:0xf
    s_nop 1
    v_add_f32_dpp v119, v119, v119 row_ror:4 row_mask:0xf bank_mask:0xf
    v_rcp_f32 v119, v119
    s_nop 0
    v_mul_f32 v116, v116, v119
    s_nop 0
    v_readlane_b32 s60, v116, 0
    v_readlane_b32 s61, v116, 1
    v_readlane_b32 s62, v116, 2
    v_readlane_b32 s63, v116, 3
    v_readlane_b32 s64, v116, 4
    v_readlane_b32 s65, v116, 5
    v_readlane_b32 s66, v116, 6
    v_readlane_b32 s67, v116, 7
    s_mov_b32 s44, 0
    s_mov_b32 s45, -1
    v_mov_b32 v116, s60
    v_mov_b32 v126, s61
    v_cndmask_b32 v116, v116, v126, s[44:45]
    v_mov_b32 v117, s62
    v_mov_b32 v126, s63
    v_cndmask_b32 v117, v117, v126, s[44:45]
    v_mov_b32 v118, s64
    v_mov_b32 v126, s65
    v_cndmask_b32 v118, v118, v126, s[44:45]
    v_mov_b32 v119, s66
    v_mov_b32 v126, s67
    v_cndmask_b32 v119, v119, v126, s[44:45]
    s_cmp_ge_u32 s52, 16
    s_cbranch_scc1 L_lv_80
    s_mov_b32 s98, 262144
L_w_81:
    ds_read_b32 v2, v15 offset:20
    s_sub_u32 s98, s98, 1
    s_cbranch_scc1 L_wd_82
    s_waitcnt lgkmcnt(0)
    v_readfirstlane_b32 s99, v2
    s_cmp_ge_u32 s99, 16
    s_cbranch_scc0 L_w_81
L_wd_82:
    s_waitcnt lgkmcnt(0)
    s_mov_b32 s52, s99
L_lv_80:
    ds_read_b64_tr_b16 v[68:69], v44 offset:49152
    ds_read_b64_tr_b16 v[72:73], v45 offset:49152
    ds_read_b64_tr_b16 v[76:77], v46 offset:49152
    ds_read_b64_tr_b16 v[80:81], v47 offset:49152
    ds_read_b64_tr_b16 v[70:71], v44 offset:57344
    ds_read_b64_tr_b16 v[74:75], v45 offset:57344
    ds_read_b64_tr_b16 v[78:79], v46 offset:57344
    ds_read_b64_tr_b16 v[82:83], v47 offset:57344
    ds_read_b128 v[84:87], v8 offset:448
    s_waitcnt lgkmcnt(9)
    v_mfma_f32_16x16x32_bf16 v[16:19], v[48:51], v[64:67], v[16:19]
    v_mfma_f32_16x16x32_bf16 v[20:23], v[52:55], v[64:67], v[20:23]
    v_mfma_f32_16x16x32_bf16 v[24:27], v[56:59], v[64:67], v[24:27]
    v_mfma_f32_16x16x32_bf16 v[28:31], v[60:63], v[64:67], v[28:31]
    s_mov_b32 s66, 0xc0c0c0c
    s_mov_b32 s67, 0xc0c0c0c
    s_mov_b32 s68, 0x30303030
    s_mov_b32 s69, 0x30303030
    s_mov_b32 s70, 0xc0c0c0c0
    s_mov_b32 s71, 0xc0c0c0c0
    s_waitcnt lgkmcnt(0)
    v_mfma_f32_16x16x32_bf16 v[16:19], v[68:71], v[84:87], v[16:19]
    v_mfma_f32_16x16x32_bf16 v[20:23], v[72:75], v[84:87], v[20:23]
    v_mfma_f32_16x16x32_bf16 v[24:27], v[76:79], v[84:87], v[24:27]
    v_mfma_f32_16x16x32_bf16 v[28:31], v[80:83], v[84:87], v[28:31]
    s_nop 5
    v_cndmask_b32 v32, v16, v20, s[66:67]
    v_cndmask_b32 v33, v17, v21, s[66:67]
    v_cndmask_b32 v34, v18, v22, s[66:67]
    v_cndmask_b32 v35, v19, v23, s[66:67]
    v_cndmask_b32 v32, v32, v24, s[68:69]
    v_cndmask_b32 v33, v33, v25, s[68:69]
    v_cndmask_b32 v34, v34, v26, s[68:69]
    v_cndmask_b32 v35, v35, v27, s[68:69]
    v_cndmask_b32 v32, v32, v28, s[70:71]
    v_cndmask_b32 v33, v33, v29, s[70:71]
    v_cndmask_b32 v34, v34, v30, s[70:71]
    v_cndmask_b32 v35, v35, v31, s[70:71]
    v_perm_b32 v32, v32, v14, s72
    v_perm_b32 v33, v33, v14, s73
    v_perm_b32 v34, v34, v14, s74
    v_perm_b32 v35, v35, v14, s75
    s_mov_b64 exec, s[58:59]
    s_cmp_lg_u32 s78, 0
    s_cbranch_scc1 L_sm_83
    buffer_store_dwordx4 v[32:35], v112, s[92:95], 0 offen
    s_branch L_sme_84
L_sm_83:
    buffer_store_dwordx4 v[32:35], v112, s[92:95], 0 offen sc1
L_sme_84:
    s_mov_b64 exec, -1
    s_cmp_ge_u32 s5, 28
    s_cbranch_scc1 L_C_end
    s_mov_b32 s98, 16384
L_og_85:
    buffer_load_dwordx4 v[48:51], v120, s[92:95], 0 offen offset:0 sc1
    buffer_load_dwordx4 v[52:55], v120, s[92:95], 0 offen offset:1024 sc1
    buffer_load_dwordx4 v[56:59], v120, s[92:95], 0 offen offset:2048 sc1
    buffer_load_dwordx4 v[60:63], v120, s[92:95], 0 offen offset:3072 sc1
L_ogc_87:
    s_sub_u32 s98, s98, 1
    s_cbranch_scc1 L_ogd_86
    s_waitcnt vmcnt(0)
    v_perm_b32 v68, v49, v48, s76
    v_perm_b32 v69, v51, v50, s77
    v_or_b32 v68, v68, v69
    v_cmp_eq_u32 s[40:41], v14, v68
    v_perm_b32 v68, v53, v52, s76
    v_perm_b32 v69, v55, v54, s77
    v_or_b32 v68, v68, v69
    v_cmp_eq_u32 s[42:43], v14, v68
    s_and_b64 s[40:41], s[40:41], s[42:43]
    v_perm_b32 v68, v57, v56, s76
    v_perm_b32 v69, v59, v58, s77
    v_or_b32 v68, v68, v69
    v_cmp_eq_u32 s[42:43], v14, v68
    s_and_b64 s[40:41], s[40:41], s[42:43]
    v_perm_b32 v68, v61, v60, s76
    v_perm_b32 v69, v63, v62, s77
    v_or_b32 v68, v68, v69
    v_cmp_eq_u32 s[42:43], v14, v68
    s_and_b64 s[40:41], s[40:41], s[42:43]
    s_cmp_eq_u64 s[40:41], -1
    s_cbranch_scc1 L_ogd_86
    s_branch L_og_85
L_ogd_86:
    s_waitcnt vmcnt(0)
    v_and_b32 v48, 0xffffff00, v48
    v_and_b32 v49, 0xffffff00, v49
    v_and_b32 v50, 0xffffff00, v50
    v_and_b32 v51, 0xffffff00, v51
    v_and_b32 v52, 0xffffff00, v52
    v_and_b32 v53, 0xffffff00, v53
    v_and_b32 v54, 0xffffff00, v54
    v_and_b32 v55, 0xffffff00, v55
    v_and_b32 v56, 0xffffff00, v56
    v_and_b32 v57, 0xffffff00, v57
    v_and_b32 v58, 0xffffff00, v58
    v_and_b32 v59, 0xffffff00, v59
    v_and_b32 v60, 0xffffff00, v60
    v_and_b32 v61, 0xffffff00, v61
    v_and_b32 v62, 0xffffff00, v62
    v_and_b32 v63, 0xffffff00, v63
    v_mul_f32 v72, v48, v116
    v_mul_f32 v73, v49, v116
    v_mul_f32 v74, v50, v116
    v_mul_f32 v75, v51, v116
    v_fmac_f32 v72, v52, v117
    v_fmac_f32 v73, v53, v117
    v_fmac_f32 v74, v54, v117
    v_fmac_f32 v75, v55, v117
    v_fmac_f32 v72, v56, v118
    v_fmac_f32 v73, v57, v118
    v_fmac_f32 v74, v58, v118
    v_fmac_f32 v75, v59, v118
    v_fmac_f32 v72, v60, v119
    v_fmac_f32 v73, v61, v119
    v_fmac_f32 v74, v62, v119
    v_fmac_f32 v75, v63, v119
    v_mov_b32 v76, v72
    v_mov_b32 v77, v73
    v_mov_b32 v78, v74
    v_mov_b32 v79, v75
    v_permlane32_swap_b32 v72, v76
    v_permlane32_swap_b32 v73, v77
    v_permlane32_swap_b32 v74, v78
    v_permlane32_swap_b32 v75, v79
    v_add_f32 v72, v72, v76
    v_add_f32 v73, v73, v77
    v_add_f32 v74, v74, v78
    v_add_f32 v75, v75, v79
    v_cvt_pk_bf16_f32 v72, v72, v73
    v_cvt_pk_bf16_f32 v73, v74, v75
    s_mov_b32 exec_lo, -1
    s_mov_b32 exec_hi, 0
    ds_write_b64 v121, v[72:73]
    s_mov_b64 exec, -1
    s_waitcnt lgkmcnt(0)
    s_mov_b64 exec, 1
    v_mov_b32 v68, 1
    ds_add_u32 v15, v68 offset:56
    s_mov_b64 exec, -1
    s_mov_b32 s98, 262144
L_w_88:
    ds_read_b32 v2, v15 offset:28
    s_sub_u32 s98, s98, 1
    s_cbranch_scc1 L_wd_89
    s_waitcnt lgkmcnt(0)
    v_readfirstlane_b32 s99, v2
    s_cmp_ge_u32 s99, 1
    s_cbranch_scc0 L_w_88
L_wd_89:
    s_waitcnt lgkmcnt(0)
    ds_read_b64_tr_b16 v[96:97], v115 offset:0
    ds_read_b64_tr_b16 v[98:99], v115 offset:2048
    ds_read_b64_tr_b16 v[100:101], v115 offset:4096
    ds_read_b64_tr_b16 v[102:103], v115 offset:6144
    ds_read_b64_tr_b16 v[104:105], v115 offset:8192
    ds_read_b64_tr_b16 v[106:107], v115 offset:10240
    ds_read_b64_tr_b16 v[108:109], v115 offset:12288
    ds_read_b64_tr_b16 v[110:111], v115 offset:14336
    s_mov_b32 s98, 262144
L_w_90:
    ds_read_b32 v68, v15 offset:56
    s_sub_u32 s98, s98, 1
    s_cbranch_scc1 L_wd_91
    s_waitcnt lgkmcnt(0)
    v_readfirstlane_b32 s99, v68
    s_cmp_ge_u32 s99, 4
    s_cbranch_scc0 L_w_90
L_wd_91:
    s_waitcnt lgkmcnt(0)
    ds_read_b128 v[48:51], v122 offset:0
    ds_read_b128 v[52:55], v122 offset:64
    ds_read_b128 v[56:59], v122 offset:128
    ds_read_b128 v[60:63], v122 offset:192
    s_waitcnt lgkmcnt(3)
    v_mfma_f32_16x16x32_bf16 v[16:19], v[96:99], v[48:51], 0
    s_waitcnt lgkmcnt(2)
    v_mfma_f32_16x16x32_bf16 v[16:19], v[100:103], v[52:55], v[16:19]
    s_waitcnt lgkmcnt(1)
    v_mfma_f32_16x16x32_bf16 v[16:19], v[104:107], v[56:59], v[16:19]
    s_waitcnt lgkmcnt(0)
    v_mfma_f32_16x16x32_bf16 v[16:19], v[108:111], v[60:63], v[16:19]
    s_nop 7
    v_perm_b32 v16, v16, v14, s72
    v_perm_b32 v17, v17, v14, s73
    v_perm_b32 v18, v18, v14, s74
    v_perm_b32 v19, v19, v14, s75
    s_mov_b32 exec_lo, 0x000f000f
    s_mov_b32 exec_hi, 0x000f000f
    buffer_store_dwordx4 v[16:19], v123, s[92:95], 0 offen sc1
    s_mov_b64 exec, -1
    s_mov_b64 exec, 1
    v_mov_b32 v68, 1
    ds_add_u32 v15, v68 offset:60
    s_mov_b64 exec, -1
L_C_end:
    s_waitcnt vmcnt(0) lgkmcnt(0)
    s_endpgm
L_F:
    v_mov_b32 v4, 0
    v_mov_b32 v5, 0
    v_mov_b32 v6, 0
    v_mov_b32 v7, 0
    v_lshlrev_b32 v2, 4, v1
    v_add_u32 v3, 155648, v2
    ds_write_b128 v3, v[4:7] offset:0
    ds_write_b128 v3, v[4:7] offset:1024
    ds_write_b128 v3, v[4:7] offset:2048
    ds_write_b128 v3, v[4:7] offset:3072
    s_mov_b64 exec, 0xffff
    ds_write_b128 v3, v[4:7] offset:4096
    s_mov_b64 exec, 0xff
    v_add_u32 v3, 163712, v2
    ds_write_b128 v3, v[4:7]
    s_mov_b64 exec, -1
    v_add_u32 v3, 112640, v2
    ds_write_b128 v3, v[4:7]
    ds_write_b128 v3, v[4:7] offset:1024
    v_add_u32 v3, 129024, v2
    ds_write_b128 v3, v[4:7]
    ds_write_b128 v3, v[4:7] offset:1024
    s_waitcnt lgkmcnt(0)
    s_lshl_b32 s34, s4, 7
    s_add_u32 s34, s34, 0
    s_add_u32 s38, s30, s34
    s_addc_u32 s39, s31, 0
    s_load_dword s33, s[38:39], 0
    s_barrier
    s_add_u32 s92, s30, 0
    s_addc_u32 s93, s31, 0
    s_mov_b32 s94, 4194304
    s_mov_b32 s95, 0x20000
    s_mov_b32 s72, 0x7060500
    s_mov_b32 s73, 0x7060501
    s_mov_b32 s74, 0x7060502
    s_mov_b32 s75, 0x7060503
    s_mov_b32 s76, 0x0c0c0400
    s_mov_b32 s77, 0x04000c0c
    v_mov_b32 v15, 163712
    v_lshrrev_b32 v11, 4, v1
    v_and_b32 v12, 15, v1
    s_mov_b32 s36, 0x000f000f
    s_mov_b32 s37, 0x000f000f
    v_and_b32 v2, 3, v1
    v_mul_u32_u24 v2, 1088, v2
    v_lshl_add_u32 v2, v11, 4, v2
    v_add_u32 v2, 155648, v2
    s_lshr_b32 s34, s5, 3
    s_lshl_b32 s34, s34, 8
    v_add_u32 v3, s34, v2
    s_lshl_b32 s34, s4, 15
    s_lshr_b32 s35, s5, 3
    s_lshl_b32 s35, s35, 11
    s_add_u32 s34, s34, s35
    s_and_b32 s35, s5, 7
    s_lshl_b32 s35, s35, 8
    s_add_u32 s34, s34, s35
    s_add_u32 s34, s34, 4096
    v_and_b32 v10, 3, v1
    v_lshlrev_b32 v9, 13, v10
    v_lshl_add_u32 v9, v11, 4, v9
    v_bfe_u32 v10, v1, 2, 2
    v_lshl_add_u32 v9, v10, 6, v9
    v_add_u32 v9, s34, v9
    s_lshl_b32 s34, s4, 15
    s_lshl_b32 s35, s6, 13
    s_add_u32 s34, s34, s35
    s_add_u32 s34, s34, 4096
    v_lshlrev_b32 v10, 4, v1
    v_add_u32 v10, s34, v10
    v_add_u32 v13, 4096, v10
    s_getreg_b32 s79, hwreg(HW_REG_XCC_ID, 0, 4)
    s_lshl_b32 s79, s79, 1
    s_waitcnt lgkmcnt(0)
    s_mul_i32 s33, s33, 0x9E3779B1
    s_add_u32 s33, s33, 0x7F4A7C15
    s_or_b32 s33, s33, 1
    v_mov_b32 v14, s33
    s_mov_b64 exec, 1
    v_mov_b32 v16, s33
    ds_write_b32 v15, v16 offset:64
    s_mov_b64 exec, -1
    s_cmp_lg_u32 s5, 0
    s_cbranch_scc1 L_nl_92
    s_mov_b64 exec, 1
    s_lshl_b32 s34, s4, 2
    v_mov_b32 v16, s34
    global_store_dword v16, v14, s[28:29] sc1
    s_mov_b64 exec, -1
L_nl_92:
    s_xor_b32 s79, s33, s79
    v_mov_b32 v6, v14
    v_mov_b32 v14, s79
    s_mov_b32 s98, 262144
L_w_93:
    ds_read_b32 v16, v15 offset:0
    s_sub_u32 s98, s98, 1
    s_cbranch_scc1 L_wd_94
    s_waitcnt lgkmcnt(0)
    v_readfirstlane_b32 s99, v16
    s_cmp_ge_u32 s99, 4
    s_cbranch_scc0 L_w_93
L_wd_94:
    s_waitcnt lgkmcnt(0)
    s_mov_b32 s98, 262144
L_w_95:
    ds_read_b32 v16, v15 offset:4
    s_sub_u32 s98, s98, 1
    s_cbranch_scc1 L_wd_96
    s_waitcnt lgkmcnt(0)
    v_readfirstlane_b32 s99, v16
    s_cmp_ge_u32 s99, 1
    s_cbranch_scc0 L_w_95
L_wd_96:
    s_waitcnt lgkmcnt(0)
    ds_read_b128 v[32:35], v3 offset:0
    ds_read_b128 v[36:39], v3 offset:64
    ds_read_b128 v[40:43], v3 offset:128
    ds_read_b128 v[44:47], v3 offset:192
    v_bfe_u32 v8, v1, 3, 2
    v_xor_b32 v8, 0, v8
    v_lshlrev_b32 v8, 5, v8
    v_lshrrev_b32 v7, 2, v1
    v_lshl_add_u32 v7, v7, 7, v8
    v_and_b32 v8, 3, v1
    v_lshl_add_u32 v7, v8, 3, v7
    v_add_u32 v7, 98304, v7
    ds_read_b64_tr_b16 v[48:49], v7 offset:0
    ds_read_b64_tr_b16 v[50:51], v7 offset:2048
    ds_read_b64_tr_b16 v[52:53], v7 offset:4096
    ds_read_b64_tr_b16 v[54:55], v7 offset:6144
    ds_read_b64_tr_b16 v[56:57], v7 offset:8192
    ds_read_b64_tr_b16 v[58:59], v7 offset:10240
    ds_read_b64_tr_b16 v[60:61], v7 offset:12288
    ds_read_b64_tr_b16 v[62:63], v7 offset:14336
    v_bfe_u32 v8, v1, 3, 2
    v_xor_b32 v8, 1, v8
    v_lshlrev_b32 v8, 5, v8
    v_lshrrev_b32 v7, 2, v1
    v_lshl_add_u32 v7, v7, 7, v8
    v_and_b32 v8, 3, v1
    v_lshl_add_u32 v7, v8, 3, v7
    v_add_u32 v7, 98304, v7
    ds_read_b64_tr_b16 v[64:65], v7 offset:0
    ds_read_b64_tr_b16 v[66:67], v7 offset:2048
    ds_read_b64_tr_b16 v[68:69], v7 offset:4096
    ds_read_b64_tr_b16 v[70:71], v7 offset:6144
    ds_read_b64_tr_b16 v[72:73], v7 offset:8192
    ds_read_b64_tr_b16 v[74:75], v7 offset:10240
    ds_read_b64_tr_b16 v[76:77], v7 offset:12288
    ds_read_b64_tr_b16 v[78:79], v7 offset:14336
    v_bfe_u32 v8, v1, 3, 2
    v_xor_b32 v8, 2, v8
    v_lshlrev_b32 v8, 5, v8
    v_lshrrev_b32 v7, 2, v1
    v_lshl_add_u32 v7, v7, 7, v8
    v_and_b32 v8, 3, v1
    v_lshl_add_u32 v7, v8, 3, v7
    v_add_u32 v7, 98304, v7
    ds_read_b64_tr_b16 v[80:81], v7 offset:0
    ds_read_b64_tr_b16 v[82:83], v7 offset:2048
    ds_read_b64_tr_b16 v[84:85], v7 offset:4096
    ds_read_b64_tr_b16 v[86:87], v7 offset:6144
    ds_read_b64_tr_b16 v[88:89], v7 offset:8192
    ds_read_b64_tr_b16 v[90:91], v7 offset:10240
    ds_read_b64_tr_b16 v[92:93], v7 offset:12288
    ds_read_b64_tr_b16 v[94:95], v7 offset:14336
    v_bfe_u32 v8, v1, 3, 2
    v_xor_b32 v8, 3, v8
    v_lshlrev_b32 v8, 5, v8
    v_lshrrev_b32 v7, 2, v1
    v_lshl_add_u32 v7, v7, 7, v8
    v_and_b32 v8, 3, v1
    v_lshl_add_u32 v7, v8, 3, v7
    v_add_u32 v7, 98304, v7
    ds_read_b64_tr_b16 v[96:97], v7 offset:0
    ds_read_b64_tr_b16 v[98:99], v7 offset:2048
    ds_read_b64_tr_b16 v[100:101], v7 offset:4096
    ds_read_b64_tr_b16 v[102:103], v7 offset:6144
    ds_read_b64_tr_b16 v[104:105], v7 offset:8192
    ds_read_b64_tr_b16 v[106:107], v7 offset:10240
    ds_read_b64_tr_b16 v[108:109], v7 offset:12288
    ds_read_b64_tr_b16 v[110:111], v7 offset:14336
    s_waitcnt lgkmcnt(0)
    s_mov_b64 exec, 1
    v_mov_b32 v8, 1
    ds_write_b32 v15, v8 offset:72
    s_mov_b64 exec, -1
    v_mfma_f32_16x16x32_bf16 v[16:19], v[48:51], v[32:35], 0
    v_mfma_f32_16x16x32_bf16 v[20:23], v[64:67], v[32:35], 0
    v_mfma_f32_16x16x32_bf16 v[24:27], v[80:83], v[32:35], 0
    v_mfma_f32_16x16x32_bf16 v[28:31], v[96:99], v[32:35], 0
    v_mfma_f32_16x16x32_bf16 v[16:19], v[52:55], v[36:39], v[16:19]
    v_mfma_f32_16x16x32_bf16 v[20:23], v[68:71], v[36:39], v[20:23]
    v_mfma_f32_16x16x32_bf16 v[24:27], v[84:87], v[36:39], v[24:27]
    v_mfma_f32_16x16x32_bf16 v[28:31], v[100:103], v[36:39], v[28:31]
    v_mfma_f32_16x16x32_bf16 v[16:19], v[56:59], v[40:43], v[16:19]
    v_mfma_f32_16x16x32_bf16 v[20:23], v[72:75], v[40:43], v[20:23]
    v_mfma_f32_16x16x32_bf16 v[24:27], v[88:91], v[40:43], v[24:27]
    v_mfma_f32_16x16x32_bf16 v[28:31], v[104:107], v[40:43], v[28:31]
    v_mfma_f32_16x16x32_bf16 v[16:19], v[60:63], v[44:47], v[16:19]
    v_mfma_f32_16x16x32_bf16 v[20:23], v[76:79], v[44:47], v[20:23]
    v_mfma_f32_16x16x32_bf16 v[24:27], v[92:95], v[44:47], v[24:27]
    v_mfma_f32_16x16x32_bf16 v[28:31], v[108:111], v[44:47], v[28:31]
    s_mov_b32 s40, 0xf000f0
    s_mov_b32 s41, 0xf000f0
    s_mov_b32 s42, 0xf000f00
    s_mov_b32 s43, 0xf000f00
    s_mov_b32 s44, 0xf000f000
    s_mov_b32 s45, 0xf000f000
    v_cndmask_b32 v112, v16, v20, s[40:41]
    v_cndmask_b32 v113, v17, v21, s[40:41]
    v_cndmask_b32 v114, v18, v22, s[40:41]
    v_cndmask_b32 v115, v19, v23, s[40:41]
    v_cndmask_b32 v112, v112, v24, s[42:43]
    v_cndmask_b32 v113, v113, v25, s[42:43]
    v_cndmask_b32 v114, v114, v26, s[42:43]
    v_cndmask_b32 v115, v115, v27, s[42:43]
    v_cndmask_b32 v112, v112, v28, s[44:45]
    v_cndmask_b32 v113, v113, v29, s[44:45]
    v_cndmask_b32 v114, v114, v30, s[44:45]
    v_cndmask_b32 v115, v115, v31, s[44:45]
    v_perm_b32 v112, v112, v14, s72
    v_perm_b32 v113, v113, v14, s73
    v_perm_b32 v114, v114, v14, s74
    v_perm_b32 v115, v115, v14, s75
    buffer_store_dwordx4 v[112:115], v9, s[92:95], 0 offen
    s_sleep 60
    s_mov_b32 s98, 16384
    s_mov_b32 s32, 0
    buffer_load_dwordx4 v[32:35], v10, s[92:95], 0 offen offset:0
    buffer_load_dwordx4 v[36:39], v10, s[92:95], 0 offen offset:1024
    buffer_load_dwordx4 v[40:43], v10, s[92:95], 0 offen offset:2048
    buffer_load_dwordx4 v[44:47], v10, s[92:95], 0 offen offset:3072
    s_waitcnt vmcnt(0)
    buffer_load_dwordx4 v[48:51], v13, s[92:95], 0 offen offset:0
    buffer_load_dwordx4 v[52:55], v13, s[92:95], 0 offen offset:1024
    buffer_load_dwordx4 v[56:59], v13, s[92:95], 0 offen offset:2048
    buffer_load_dwordx4 v[60:63], v13, s[92:95], 0 offen offset:3072
    s_branch L_qgc_100
L_qg_97:
    buffer_load_dwordx4 v[32:35], v10, s[92:95], 0 offen offset:0 sc1
    buffer_load_dwordx4 v[36:39], v10, s[92:95], 0 offen offset:1024 sc1
    buffer_load_dwordx4 v[40:43], v10, s[92:95], 0 offen offset:2048 sc1
    buffer_load_dwordx4 v[44:47], v10, s[92:95], 0 offen offset:3072 sc1
    s_waitcnt vmcnt(0)
    buffer_load_dwordx4 v[48:51], v13, s[92:95], 0 offen offset:0 sc1
    buffer_load_dwordx4 v[52:55], v13, s[92:95], 0 offen offset:1024 sc1
    buffer_load_dwordx4 v[56:59], v13, s[92:95], 0 offen offset:2048 sc1
    buffer_load_dwordx4 v[60:63], v13, s[92:95], 0 offen offset:3072 sc1
L_qgc_100:
    s_sub_u32 s98, s98, 1
    s_cbranch_scc1 L_qgd_98
    s_waitcnt vmcnt(0)
    v_perm_b32 v64, v33, v32, s76
    v_perm_b32 v65, v35, v34, s77
    v_or_b32 v64, v64, v65
    v_xor_b32 v66, v14, v64
    v_perm_b32 v64, v37, v36, s76
    v_perm_b32 v65, v39, v38, s77
    v_or_b32 v64, v64, v65
    v_xor_b32 v64, v14, v64
    v_or_b32 v66, v66, v64
    v_perm_b32 v64, v41, v40, s76
    v_perm_b32 v65, v43, v42, s77
    v_or_b32 v64, v64, v65
    v_xor_b32 v64, v14, v64
    v_or_b32 v66, v66, v64
    v_perm_b32 v64, v45, v44, s76
    v_perm_b32 v65, v47, v46, s77
    v_or_b32 v64, v64, v65
    v_xor_b32 v64, v14, v64
    v_or_b32 v66, v66, v64
    v_perm_b32 v64, v49, v48, s76
    v_perm_b32 v65, v51, v50, s77
    v_or_b32 v64, v64, v65
    v_xor_b32 v64, v14, v64
    v_or_b32 v66, v66, v64
    v_perm_b32 v64, v53, v52, s76
    v_perm_b32 v65, v55, v54, s77
    v_or_b32 v64, v64, v65
    v_xor_b32 v64, v14, v64
    v_or_b32 v66, v66, v64
    v_perm_b32 v64, v57, v56, s76
    v_perm_b32 v65, v59, v58, s77
    v_or_b32 v64, v64, v65
    v_xor_b32 v64, v14, v64
    v_or_b32 v66, v66, v64
    v_perm_b32 v64, v61, v60, s76
    v_perm_b32 v65, v63, v62, s77
    v_or_b32 v64, v64, v65
    v_xor_b32 v64, v14, v64
    v_or_b32 v66, v66, v64
    v_and_b32 v64, 0xffffffe1, v66
    v_cmp_eq_u32 s[40:41], 0, v64
    s_cmp_eq_u64 s[40:41], -1
    s_cbranch_scc1 L_qgd_98
    s_add_u32 s32, s32, 1
    s_cmp_lg_u32 s32, 12
    s_cbranch_scc1 L_qnf_99
    buffer_store_dwordx4 v[112:115], v9, s[92:95], 0 offen sc1
L_qnf_99:
    s_sleep 2
    s_branch L_qg_97
L_qgd_98:
    s_waitcnt vmcnt(0)
    v_cmp_eq_u32 s[40:41], 0, v66
    s_cmp_eq_u64 s[40:41], -1
    s_cselect_b32 s78, 0, 1
    s_cmp_eq_u32 s78, 0
    s_cbranch_scc1 L_loc_101
    buffer_store_dwordx4 v[112:115], v9, s[92:95], 0 offen sc1
L_loc_101:
    s_add_u32 s34, s78, 1
    s_mov_b64 exec, 1
    v_mov_b32 v16, s34
    ds_write_b32 v15, v16 offset:68
    s_mov_b64 exec, -1
    v_mov_b32 v14, v6
    v_and_b32 v32, 0xffffff00, v32
    v_and_b32 v33, 0xffffff00, v33
    v_and_b32 v34, 0xffffff00, v34
    v_and_b32 v35, 0xffffff00, v35
    v_and_b32 v36, 0xffffff00, v36
    v_and_b32 v37, 0xffffff00, v37
    v_and_b32 v38, 0xffffff00, v38
    v_and_b32 v39, 0xffffff00, v39
    v_and_b32 v40, 0xffffff00, v40
    v_and_b32 v41, 0xffffff00, v41
    v_and_b32 v42, 0xffffff00, v42
    v_and_b32 v43, 0xffffff00, v43
    v_and_b32 v44, 0xffffff00, v44
    v_and_b32 v45, 0xffffff00, v45
    v_and_b32 v46, 0xffffff00, v46
    v_and_b32 v47, 0xffffff00, v47
    v_and_b32 v48, 0xffffff00, v48
    v_and_b32 v49, 0xffffff00, v49
    v_and_b32 v50, 0xffffff00, v50
    v_and_b32 v51, 0xffffff00, v51
    v_and_b32 v52, 0xffffff00, v52
    v_and_b32 v53, 0xffffff00, v53
    v_and_b32 v54, 0xffffff00, v54
    v_and_b32 v55, 0xffffff00, v55
    v_and_b32 v56, 0xffffff00, v56
    v_and_b32 v57, 0xffffff00, v57
    v_and_b32 v58, 0xffffff00, v58
    v_and_b32 v59, 0xffffff00, v59
    v_and_b32 v60, 0xffffff00, v60
    v_and_b32 v61, 0xffffff00, v61
    v_and_b32 v62, 0xffffff00, v62
    v_and_b32 v63, 0xffffff00, v63
    v_add_f32 v64, v32, v40
    v_add_f32 v72, v48, v56
    v_add_f32 v64, v64, v72
    v_add_f32 v65, v33, v41
    v_add_f32 v73, v49, v57
    v_add_f32 v65, v65, v73
    v_add_f32 v66, v34, v42
    v_add_f32 v74, v50, v58
    v_add_f32 v66, v66, v74
    v_add_f32 v67, v35, v43
    v_add_f32 v75, v51, v59
    v_add_f32 v67, v67, v75
    v_cvt_pk_bf16_f32 v80, v64, v65
    v_cvt_pk_bf16_f32 v81, v66, v67
    v_add_f32 v68, v36, v44
    v_add_f32 v76, v52, v60
    v_add_f32 v68, v68, v76
    v_add_f32 v69, v37, v45
    v_add_f32 v77, v53, v61
    v_add_f32 v69, v69, v77
    v_add_f32 v70, v38, v46
    v_add_f32 v78, v54, v62
    v_add_f32 v70, v70, v78
    v_add_f32 v71, v39, v47
    v_add_f32 v79, v55, v63
    v_add_f32 v71, v71, v79
    v_cvt_pk_bf16_f32 v82, v68, v69
    v_cvt_pk_bf16_f32 v83, v70, v71
    v_lshlrev_b32 v25, 3, v1
    v_add_u32 v25, 160000, v25
    ds_write_b64 v25, v[80:81]
    ds_write_b64 v25, v[82:83] offset:512
    s_waitcnt lgkmcnt(0)
    s_mov_b64 exec, 1
    v_mov_b32 v16, 1
    ds_write_b32 v15, v16 offset:24
    s_mov_b64 exec, -1
    s_cmp_lg_u32 s5, 0
    s_cbranch_scc1 L_nl2_102
    s_mov_b64 exec, 1
    s_lshl_b32 s34, s4, 7
    v_mov_b32 v24, s34
    buffer_store_dword v14, v24, s[92:95], 0 offen offset:0 sc1
    s_mov_b64 exec, -1
L_nl2_102:
    s_waitcnt vmcnt(0) lgkmcnt(0)
    s_endpgm
L_G:
    s_waitcnt lgkmcnt(0)
    s_barrier
    s_add_u32 s92, s30, 0
    s_addc_u32 s93, s31, 0
    s_mov_b32 s94, 4194304
    s_mov_b32 s95, 0x20000
    s_mov_b32 s72, 0x7060500
    s_mov_b32 s73, 0x7060501
    s_mov_b32 s74, 0x7060502
    s_mov_b32 s75, 0x7060503
    s_mov_b32 s76, 0x0c0c0400
    s_mov_b32 s77, 0x04000c0c
    v_mov_b32 v15, 163712
    v_lshrrev_b32 v11, 4, v1
    v_and_b32 v12, 15, v1
    s_mov_b32 s36, 0x000f000f
    s_mov_b32 s37, 0x000f000f
    v_and_b32 v2, 3, v1
    v_mul_u32_u24 v2, 1088, v2
    v_lshl_add_u32 v2, v11, 4, v2
    v_add_u32 v2, 155648, v2
    s_mov_b32 s98, 262144
L_w_103:
    ds_read_b32 v16, v15 offset:64
    s_sub_u32 s98, s98, 1
    s_cbranch_scc1 L_wd_104
    s_waitcnt lgkmcnt(0)
    v_readfirstlane_b32 s99, v16
    s_cmp_ge_u32 s99, 1
    s_cbranch_scc1 L_wd_104
    s_sleep 1
    s_branch L_w_103
L_wd_104:
    s_waitcnt lgkmcnt(0)
    s_mov_b32 s33, s99
    v_mov_b32 v14, s99
    s_lshr_b32 s56, s5, 3
    s_bfe_u32 s57, s5, 0x10002
    s_and_b32 s58, s5, 3
    s_lshl_b32 s34, s56, 3
    s_add_u32 s59, s34, s4
    s_cmp_ge_u32 s59, 28
    s_cbranch_scc1 L_G_not2
    s_lshl_b32 s34, s58, 8
    v_add_u32 v3, s34, v2
    s_lshl_b32 s34, s4, 15
    s_lshl_b32 s35, s56, 13
    s_add_u32 s34, s34, s35
    s_lshl_b32 s35, s57, 12
    s_add_u32 s34, s34, s35
    s_lshl_b32 s35, s58, 10
    s_add_u32 s34, s34, s35
    s_add_u32 s34, s34, 327680
    v_and_b32 v10, 3, v1
    v_lshlrev_b32 v9, 8, v10
    v_lshl_add_u32 v9, v11, 4, v9
    v_bfe_u32 v10, v1, 2, 2
    v_lshl_add_u32 v9, v10, 6, v9
    v_add_u32 v9, s34, v9
    s_mov_b32 s98, 262144
L_w_105:
    ds_read_b32 v16, v15 offset:0
    s_sub_u32 s98, s98, 1
    s_cbranch_scc1 L_wd_106
    s_waitcnt lgkmcnt(0)
    v_readfirstlane_b32 s99, v16
    s_cmp_ge_u32 s99, 4
    s_cbranch_scc1 L_wd_106
    s_sleep 1
    s_branch L_w_105
L_wd_106:
    s_waitcnt lgkmcnt(0)
    s_mov_b32 s98, 262144
L_w_107:
    ds_read_b32 v16, v15 offset:8
    s_sub_u32 s98, s98, 1
    s_cbranch_scc1 L_wd_108
    s_waitcnt lgkmcnt(0)
    v_readfirstlane_b32 s99, v16
    s_cmp_ge_u32 s99, 1
    s_cbranch_scc1 L_wd_108
    s_sleep 2
    s_branch L_w_107
L_wd_108:
    s_waitcnt lgkmcnt(0)
    ds_read_b128 v[32:35], v3 offset:0
    ds_read_b128 v[36:39], v3 offset:64
    ds_read_b128 v[40:43], v3 offset:128
    ds_read_b128 v[44:47], v3 offset:192
    v_bfe_u32 v8, v1, 3, 2
    v_xor_b32 v8, 0, v8
    v_lshlrev_b32 v8, 5, v8
    v_lshrrev_b32 v7, 2, v1
    v_lshl_add_u32 v7, v7, 7, v8
    v_and_b32 v8, 3, v1
    v_lshl_add_u32 v7, v8, 3, v7
    v_add_u32 v7, 114688, v7
    ds_read_b64_tr_b16 v[48:49], v7 offset:0
    ds_read_b64_tr_b16 v[50:51], v7 offset:2048
    ds_read_b64_tr_b16 v[52:53], v7 offset:4096
    ds_read_b64_tr_b16 v[54:55], v7 offset:6144
    ds_read_b64_tr_b16 v[56:57], v7 offset:8192
    ds_read_b64_tr_b16 v[58:59], v7 offset:10240
    ds_read_b64_tr_b16 v[60:61], v7 offset:12288
    ds_read_b64_tr_b16 v[62:63], v7 offset:14336
    v_bfe_u32 v8, v1, 3, 2
    v_xor_b32 v8, 1, v8
    v_lshlrev_b32 v8, 5, v8
    v_lshrrev_b32 v7, 2, v1
    v_lshl_add_u32 v7, v7, 7, v8
    v_and_b32 v8, 3, v1
    v_lshl_add_u32 v7, v8, 3, v7
    v_add_u32 v7, 114688, v7
    ds_read_b64_tr_b16 v[64:65], v7 offset:0
    ds_read_b64_tr_b16 v[66:67], v7 offset:2048
    ds_read_b64_tr_b16 v[68:69], v7 offset:4096
    ds_read_b64_tr_b16 v[70:71], v7 offset:6144
    ds_read_b64_tr_b16 v[72:73], v7 offset:8192
    ds_read_b64_tr_b16 v[74:75], v7 offset:10240
    ds_read_b64_tr_b16 v[76:77], v7 offset:12288
    ds_read_b64_tr_b16 v[78:79], v7 offset:14336
    v_bfe_u32 v8, v1, 3, 2
    v_xor_b32 v8, 2, v8
    v_lshlrev_b32 v8, 5, v8
    v_lshrrev_b32 v7, 2, v1
    v_lshl_add_u32 v7, v7, 7, v8
    v_and_b32 v8, 3, v1
    v_lshl_add_u32 v7, v8, 3, v7
    v_add_u32 v7, 114688, v7
    ds_read_b64_tr_b16 v[80:81], v7 offset:0
    ds_read_b64_tr_b16 v[82:83], v7 offset:2048
    ds_read_b64_tr_b16 v[84:85], v7 offset:4096
    ds_read_b64_tr_b16 v[86:87], v7 offset:6144
    ds_read_b64_tr_b16 v[88:89], v7 offset:8192
    ds_read_b64_tr_b16 v[90:91], v7 offset:10240
    ds_read_b64_tr_b16 v[92:93], v7 offset:12288
    ds_read_b64_tr_b16 v[94:95], v7 offset:14336
    v_bfe_u32 v8, v1, 3, 2
    v_xor_b32 v8, 3, v8
    v_lshlrev_b32 v8, 5, v8
    v_lshrrev_b32 v7, 2, v1
    v_lshl_add_u32 v7, v7, 7, v8
    v_and_b32 v8, 3, v1
    v_lshl_add_u32 v7, v8, 3, v7
    v_add_u32 v7, 114688, v7
    ds_read_b64_tr_b16 v[96:97], v7 offset:0
    ds_read_b64_tr_b16 v[98:99], v7 offset:2048
    ds_read_b64_tr_b16 v[100:101], v7 offset:4096
    ds_read_b64_tr_b16 v[102:103], v7 offset:6144
    ds_read_b64_tr_b16 v[104:105], v7 offset:8192
    ds_read_b64_tr_b16 v[106:107], v7 offset:10240
    ds_read_b64_tr_b16 v[108:109], v7 offset:12288
    ds_read_b64_tr_b16 v[110:111], v7 offset:14336
    s_waitcnt lgkmcnt(0)
    s_mov_b64 exec, 1
    v_mov_b32 v8, 1
    ds_write_b32 v15, v8 offset:76
    s_mov_b64 exec, -1
    v_mfma_f32_16x16x32_bf16 v[16:19], v[48:51], v[32:35], 0
    v_mfma_f32_16x16x32_bf16 v[20:23], v[64:67], v[32:35], 0
    v_mfma_f32_16x16x32_bf16 v[24:27], v[80:83], v[32:35], 0
    v_mfma_f32_16x16x32_bf16 v[28:31], v[96:99], v[32:35], 0
    v_mfma_f32_16x16x32_bf16 v[16:19], v[52:55], v[36:39], v[16:19]
    v_mfma_f32_16x16x32_bf16 v[20:23], v[68:71], v[36:39], v[20:23]
    v_mfma_f32_16x16x32_bf16 v[24:27], v[84:87], v[36:39], v[24:27]
    v_mfma_f32_16x16x32_bf16 v[28:31], v[100:103], v[36:39], v[28:31]
    v_mfma_f32_16x16x32_bf16 v[16:19], v[56:59], v[40:43], v[16:19]
    v_mfma_f32_16x16x32_bf16 v[20:23], v[72:75], v[40:43], v[20:23]
    v_mfma_f32_16x16x32_bf16 v[24:27], v[88:91], v[40:43], v[24:27]
    v_mfma_f32_16x16x32_bf16 v[28:31], v[104:107], v[40:43], v[28:31]
    v_mfma_f32_16x16x32_bf16 v[16:19], v[60:63], v[44:47], v[16:19]
    v_mfma_f32_16x16x32_bf16 v[20:23], v[76:79], v[44:47], v[20:23]
    v_mfma_f32_16x16x32_bf16 v[24:27], v[92:95], v[44:47], v[24:27]
    v_mfma_f32_16x16x32_bf16 v[28:31], v[108:111], v[44:47], v[28:31]
    s_mov_b32 s40, 0xf000f0
    s_mov_b32 s41, 0xf000f0
    s_mov_b32 s42, 0xf000f00
    s_mov_b32 s43, 0xf000f00
    s_mov_b32 s44, 0xf000f000
    s_mov_b32 s45, 0xf000f000
    v_cndmask_b32 v112, v16, v20, s[40:41]
    v_cndmask_b32 v113, v17, v21, s[40:41]
    v_cndmask_b32 v114, v18, v22, s[40:41]
    v_cndmask_b32 v115, v19, v23, s[40:41]
    v_cndmask_b32 v112, v112, v24, s[42:43]
    v_cndmask_b32 v113, v113, v25, s[42:43]
    v_cndmask_b32 v114, v114, v26, s[42:43]
    v_cndmask_b32 v115, v115, v27, s[42:43]
    v_cndmask_b32 v112, v112, v28, s[44:45]
    v_cndmask_b32 v113, v113, v29, s[44:45]
    v_cndmask_b32 v114, v114, v30, s[44:45]
    v_cndmask_b32 v115, v115, v31, s[44:45]
    v_perm_b32 v112, v112, v14, s72
    v_perm_b32 v113, v113, v14, s73
    v_perm_b32 v114, v114, v14, s74
    v_perm_b32 v115, v115, v14, s75
    buffer_store_dwordx4 v[112:115], v9, s[92:95], 0 offen
    s_mov_b32 s98, 262144
L_w_109:
    ds_read_b32 v16, v15 offset:68
    s_sub_u32 s98, s98, 1
    s_cbranch_scc1 L_wd_110
    s_waitcnt lgkmcnt(0)
    v_readfirstlane_b32 s99, v16
    s_cmp_ge_u32 s99, 1
    s_cbranch_scc1 L_wd_110
    s_sleep 2
    s_branch L_w_109
L_wd_110:
    s_waitcnt lgkmcnt(0)
    s_cmp_eq_u32 s99, 1
    s_cbranch_scc1 L_loc2_111
    buffer_store_dwordx4 v[112:115], v9, s[92:95], 0 offen sc1
L_loc2_111:
    s_branch L_G_t3
L_G_not2:
    s_mov_b64 exec, 1
    v_mov_b32 v8, 1
    ds_write_b32 v15, v8 offset:76
    s_mov_b64 exec, -1
L_G_t3:
    s_min_u32 s34, s5, 27
    s_mul_i32 s56, s34, 37
    s_lshr_b32 s56, s56, 8
    s_mul_i32 s57, s56, 7
    s_sub_u32 s57, s34, s57
    s_lshl_b32 s34, s56, 3
    s_add_u32 s59, s34, s4
    s_cmp_ge_u32 s5, 28
    s_cbranch_scc1 L_G_red
    s_cmp_ge_u32 s59, 28
    s_cbranch_scc1 L_G_red
    s_lshl_b32 s34, s4, 15
    s_lshl_b32 s35, s56, 13
    s_add_u32 s34, s34, s35
    s_add_u32 s34, s34, 327680
    v_lshlrev_b32 v10, 4, v1
    v_add_u32 v10, s34, v10
    v_add_u32 v13, 4096, v10
    s_mov_b32 s98, 262144
L_w_112:
    ds_read_b32 v16, v15 offset:68
    s_sub_u32 s98, s98, 1
    s_cbranch_scc1 L_wd_113
    s_waitcnt lgkmcnt(0)
    v_readfirstlane_b32 s99, v16
    s_cmp_ge_u32 s99, 1
    s_cbranch_scc1 L_wd_113
    s_sleep 2
    s_branch L_w_112
L_wd_113:
    s_waitcnt lgkmcnt(0)
    s_mov_b32 s98, 16384
    buffer_load_dwordx4 v[32:35], v10, s[92:95], 0 offen offset:0
    buffer_load_dwordx4 v[36:39], v10, s[92:95], 0 offen offset:1024
    buffer_load_dwordx4 v[40:43], v10, s[92:95], 0 offen offset:2048
    buffer_load_dwordx4 v[44:47], v10, s[92:95], 0 offen offset:3072
    s_waitcnt vmcnt(0)
    buffer_load_dwordx4 v[48:51], v13, s[92:95], 0 offen offset:0
    buffer_load_dwordx4 v[52:55], v13, s[92:95], 0 offen offset:1024
    buffer_load_dwordx4 v[56:59], v13, s[92:95], 0 offen offset:2048
    buffer_load_dwordx4 v[60:63], v13, s[92:95], 0 offen offset:3072
    s_branch L_ggc_116
L_gg_114:
    buffer_load_dwordx4 v[32:35], v10, s[92:95], 0 offen offset:0 sc1
    buffer_load_dwordx4 v[36:39], v10, s[92:95], 0 offen offset:1024 sc1
    buffer_load_dwordx4 v[40:43], v10, s[92:95], 0 offen offset:2048 sc1
    buffer_load_dwordx4 v[44:47], v10, s[92:95], 0 offen offset:3072 sc1
    s_waitcnt vmcnt(0)
    buffer_load_dwordx4 v[48:51], v13, s[92:95], 0 offen offset:0 sc1
    buffer_load_dwordx4 v[52:55], v13, s[92:95], 0 offen offset:1024 sc1
    buffer_load_dwordx4 v[56:59], v13, s[92:95], 0 offen offset:2048 sc1
    buffer_load_dwordx4 v[60:63], v13, s[92:95], 0 offen offset:3072 sc1
L_ggc_116:
    s_sub_u32 s98, s98, 1
    s_cbranch_scc1 L_ggd_115
    s_waitcnt vmcnt(0)
    v_perm_b32 v64, v33, v32, s76
    v_perm_b32 v65, v35, v34, s77
    v_or_b32 v64, v64, v65
    v_cmp_eq_u32 s[40:41], v14, v64
    v_perm_b32 v64, v37, v36, s76
    v_perm_b32 v65, v39, v38, s77
    v_or_b32 v64, v64, v65
    v_cmp_eq_u32 s[42:43], v14, v64
    s_and_b64 s[40:41], s[40:41], s[42:43]
    v_perm_b32 v64, v41, v40, s76
    v_perm_b32 v65, v43, v42, s77
    v_or_b32 v64, v64, v65
    v_cmp_eq_u32 s[42:43], v14, v64
    s_and_b64 s[40:41], s[40:41], s[42:43]
    v_perm_b32 v64, v45, v44, s76
    v_perm_b32 v65, v47, v46, s77
    v_or_b32 v64, v64, v65
    v_cmp_eq_u32 s[42:43], v14, v64
    s_and_b64 s[40:41], s[40:41], s[42:43]
    v_perm_b32 v64, v49, v48, s76
    v_perm_b32 v65, v51, v50, s77
    v_or_b32 v64, v64, v65
    v_cmp_eq_u32 s[42:43], v14, v64
    s_and_b64 s[40:41], s[40:41], s[42:43]
    v_perm_b32 v64, v53, v52, s76
    v_perm_b32 v65, v55, v54, s77
    v_or_b32 v64, v64, v65
    v_cmp_eq_u32 s[42:43], v14, v64
    s_and_b64 s[40:41], s[40:41], s[42:43]
    v_perm_b32 v64, v57, v56, s76
    v_perm_b32 v65, v59, v58, s77
    v_or_b32 v64, v64, v65
    v_cmp_eq_u32 s[42:43], v14, v64
    s_and_b64 s[40:41], s[40:41], s[42:43]
    v_perm_b32 v64, v61, v60, s76
    v_perm_b32 v65, v63, v62, s77
    v_or_b32 v64, v64, v65
    v_cmp_eq_u32 s[42:43], v14, v64
    s_and_b64 s[40:41], s[40:41], s[42:43]
    s_cmp_eq_u64 s[40:41], -1
    s_cbranch_scc1 L_ggd_115
    s_sleep 2
    s_branch L_gg_114
L_ggd_115:
    s_waitcnt vmcnt(0)
    v_and_b32 v32, 0xffffff00, v32
    v_and_b32 v33, 0xffffff00, v33
    v_and_b32 v34, 0xffffff00, v34
    v_and_b32 v35, 0xffffff00, v35
    v_and_b32 v36, 0xffffff00, v36
    v_and_b32 v37, 0xffffff00, v37
    v_and_b32 v38, 0xffffff00, v38
    v_and_b32 v39, 0xffffff00, v39
    v_and_b32 v40, 0xffffff00, v40
    v_and_b32 v41, 0xffffff00, v41
    v_and_b32 v42, 0xffffff00, v42
    v_and_b32 v43, 0xffffff00, v43
    v_and_b32 v44, 0xffffff00, v44
    v_and_b32 v45, 0xffffff00, v45
    v_and_b32 v46, 0xffffff00, v46
    v_and_b32 v47, 0xffffff00, v47
    v_and_b32 v48, 0xffffff00, v48
    v_and_b32 v49, 0xffffff00, v49
    v_and_b32 v50, 0xffffff00, v50
    v_and_b32 v51, 0xffffff00, v51
    v_and_b32 v52, 0xffffff00, v52
    v_and_b32 v53, 0xffffff00, v53
    v_and_b32 v54, 0xffffff00, v54
    v_and_b32 v55, 0xffffff00, v55
    v_and_b32 v56, 0xffffff00, v56
    v_and_b32 v57, 0xffffff00, v57
    v_and_b32 v58, 0xffffff00, v58
    v_and_b32 v59, 0xffffff00, v59
    v_and_b32 v60, 0xffffff00, v60
    v_and_b32 v61, 0xffffff00, v61
    v_and_b32 v62, 0xffffff00, v62
    v_and_b32 v63, 0xffffff00, v63
    v_add_f32 v64, v32, v36
    v_add_f32 v68, v40, v44
    v_add_f32 v64, v64, v68
    v_add_f32 v72, v48, v52
    v_add_f32 v76, v56, v60
    v_add_f32 v72, v72, v76
    v_add_f32 v65, v33, v37
    v_add_f32 v69, v41, v45
    v_add_f32 v65, v65, v69
    v_add_f32 v73, v49, v53
    v_add_f32 v77, v57, v61
    v_add_f32 v73, v73, v77
    v_add_f32 v66, v34, v38
    v_add_f32 v70, v42, v46
    v_add_f32 v66, v66, v70
    v_add_f32 v74, v50, v54
    v_add_f32 v78, v58, v62
    v_add_f32 v74, v74, v78
    v_add_f32 v67, v35, v39
    v_add_f32 v71, v43, v47
    v_add_f32 v67, v67, v71
    v_add_f32 v75, v51, v55
    v_add_f32 v79, v59, v63
    v_add_f32 v75, v75, v79
    v_cvt_pk_bf16_f32 v80, v64, v65
    v_lshlrev_b32 v64, 16, v80
    v_and_b32 v65, 0xffff0000, v80
    v_cvt_pk_bf16_f32 v81, v72, v73
    v_lshlrev_b32 v72, 16, v81
    v_and_b32 v73, 0xffff0000, v81
    v_cvt_pk_bf16_f32 v80, v66, v67
    v_lshlrev_b32 v66, 16, v80
    v_and_b32 v67, 0xffff0000, v80
    v_cvt_pk_bf16_f32 v81, v74, v75
    v_lshlrev_b32 v74, 16, v81
    v_and_b32 v75, 0xffff0000, v81
    v_cmp_lt_f32 vcc, 0, v64
    s_nop 1
    v_cndmask_b32 v80, 0, 1.0, vcc
    v_mul_f32 v64, v64, v80
    v_mul_f32 v64, v64, v72
    v_cmp_lt_f32 vcc, 0, v65
    s_nop 1
    v_cndmask_b32 v80, 0, 1.0, vcc
    v_mul_f32 v65, v65, v80
    v_mul_f32 v65, v65, v73
    v_cmp_lt_f32 vcc, 0, v66
    s_nop 1
    v_cndmask_b32 v80, 0, 1.0, vcc
    v_mul_f32 v66, v66, v80
    v_mul_f32 v66, v66, v74
    v_cmp_lt_f32 vcc, 0, v67
    s_nop 1
    v_cndmask_b32 v80, 0, 1.0, vcc
    v_mul_f32 v67, v67, v80
    v_mul_f32 v67, v67, v75
    v_cvt_pk_bf16_f32 v80, v64, v65
    v_cvt_pk_bf16_f32 v81, v66, v67
    s_mov_b32 s98, 262144
L_w_117:
    ds_read_b32 v16, v15 offset:72
    s_sub_u32 s98, s98, 1
    s_cbranch_scc1 L_wd_118
    s_waitcnt lgkmcnt(0)
    v_readfirstlane_b32 s99, v16
    s_cmp_ge_u32 s99, 1
    s_cbranch_scc0 L_w_117
L_wd_118:
    s_waitcnt lgkmcnt(0)
    v_lshrrev_b32 v25, 3, v12
    v_lshlrev_b32 v25, 6, v25
    v_and_b32 v26, 3, v12
    v_lshl_add_u32 v25, v26, 4, v25
    v_bfe_u32 v26, v12, 2, 1
    v_lshl_add_u32 v25, v26, 3, v25
    v_lshl_add_u32 v25, v11, 7, v25
    v_add_u32 v25, 155648, v25
    ds_write_b64 v25, v[80:81]
    v_and_b32 v3, 3, v1
    v_lshlrev_b32 v3, 7, v3
    v_lshl_add_u32 v3, v11, 4, v3
    v_add_u32 v3, 155648, v3
    s_lshl_b32 s34, s57, 13
    s_lshl_b32 s35, s59, 8
    s_add_u32 s34, s34, s35
    s_add_u32 s34, s34, 1179648
    v_and_b32 v10, 3, v1
    v_mul_u32_u24 v9, 7168, v10
    v_lshlrev_b32 v9, 3, v9
    v_lshl_add_u32 v9, v11, 4, v9
    v_bfe_u32 v10, v1, 2, 2
    v_lshl_add_u32 v9, v10, 6, v9
    v_add_u32 v9, s34, v9
    s_mov_b32 s98, 262144
L_w_119:
    ds_read_b32 v16, v15 offset:16
    s_sub_u32 s98, s98, 1
    s_cbranch_scc1 L_wd_120
    s_waitcnt lgkmcnt(0)
    v_readfirstlane_b32 s99, v16
    s_cmp_ge_u32 s99, 1
    s_cbranch_scc1 L_wd_120
    s_sleep 2
    s_branch L_w_119
L_wd_120:
    s_waitcnt lgkmcnt(0)
    ds_read_b128 v[32:35], v3 offset:0
    ds_read_b128 v[36:39], v3 offset:64
    v_bfe_u32 v8, v1, 3, 2
    v_xor_b32 v8, 0, v8
    v_lshlrev_b32 v8, 5, v8
    v_lshrrev_b32 v7, 2, v1
    v_lshl_add_u32 v7, v7, 7, v8
    v_and_b32 v8, 3, v1
    v_lshl_add_u32 v7, v8, 3, v7
    v_add_u32 v7, 147456, v7
    ds_read_b64_tr_b16 v[40:41], v7 offset:0
    ds_read_b64_tr_b16 v[42:43], v7 offset:2048
    ds_read_b64_tr_b16 v[44:45], v7 offset:4096
    ds_read_b64_tr_b16 v[46:47], v7 offset:6144
    v_bfe_u32 v8, v1, 3, 2
    v_xor_b32 v8, 1, v8
    v_lshlrev_b32 v8, 5, v8
    v_lshrrev_b32 v7, 2, v1
    v_lshl_add_u32 v7, v7, 7, v8
    v_and_b32 v8, 3, v1
    v_lshl_add_u32 v7, v8, 3, v7
    v_add_u32 v7, 147456, v7
    ds_read_b64_tr_b16 v[48:49], v7 offset:0
    ds_read_b64_tr_b16 v[50:51], v7 offset:2048
    ds_read_b64_tr_b16 v[52:53], v7 offset:4096
    ds_read_b64_tr_b16 v[54:55], v7 offset:6144
    v_bfe_u32 v8, v1, 3, 2
    v_xor_b32 v8, 2, v8
    v_lshlrev_b32 v8, 5, v8
    v_lshrrev_b32 v7, 2, v1
    v_lshl_add_u32 v7, v7, 7, v8
    v_and_b32 v8, 3, v1
    v_lshl_add_u32 v7, v8, 3, v7
    v_add_u32 v7, 147456, v7
    ds_read_b64_tr_b16 v[56:57], v7 offset:0
    ds_read_b64_tr_b16 v[58:59], v7 offset:2048
    ds_read_b64_tr_b16 v[60:61], v7 offset:4096
    ds_read_b64_tr_b16 v[62:63], v7 offset:6144
    v_bfe_u32 v8, v1, 3, 2
    v_xor_b32 v8, 3, v8
    v_lshlrev_b32 v8, 5, v8
    v_lshrrev_b32 v7, 2, v1
    v_lshl_add_u32 v7, v7, 7, v8
    v_and_b32 v8, 3, v1
    v_lshl_add_u32 v7, v8, 3, v7
    v_add_u32 v7, 147456, v7
    ds_read_b64_tr_b16 v[64:65], v7 offset:0
    ds_read_b64_tr_b16 v[66:67], v7 offset:2048
    ds_read_b64_tr_b16 v[68:69], v7 offset:4096
    ds_read_b64_tr_b16 v[70:71], v7 offset:6144
    s_waitcnt lgkmcnt(0)
    v_mfma_f32_16x16x32_bf16 v[16:19], v[40:43], v[32:35], 0
    v_mfma_f32_16x16x32_bf16 v[20:23], v[48:51], v[32:35], 0
    v_mfma_f32_16x16x32_bf16 v[24:27], v[56:59], v[32:35], 0
    v_mfma_f32_16x16x32_bf16 v[28:31], v[64:67], v[32:35], 0
    v_mfma_f32_16x16x32_bf16 v[16:19], v[44:47], v[36:39], v[16:19]
    v_mfma_f32_16x16x32_bf16 v[20:23], v[52:55], v[36:39], v[20:23]
    v_mfma_f32_16x16x32_bf16 v[24:27], v[60:63], v[36:39], v[24:27]
    v_mfma_f32_16x16x32_bf16 v[28:31], v[68:71], v[36:39], v[28:31]
    s_mov_b32 s40, 0xf000f0
    s_mov_b32 s41, 0xf000f0
    s_mov_b32 s42, 0xf000f00
    s_mov_b32 s43, 0xf000f00
    s_mov_b32 s44, 0xf000f000
    s_mov_b32 s45, 0xf000f000
    v_cndmask_b32 v112, v16, v20, s[40:41]
    v_cndmask_b32 v113, v17, v21, s[40:41]
    v_cndmask_b32 v114, v18, v22, s[40:41]
    v_cndmask_b32 v115, v19, v23, s[40:41]
    v_cndmask_b32 v112, v112, v24, s[42:43]
    v_cndmask_b32 v113, v113, v25, s[42:43]
    v_cndmask_b32 v114, v114, v26, s[42:43]
    v_cndmask_b32 v115, v115, v27, s[42:43]
    v_cndmask_b32 v112, v112, v28, s[44:45]
    v_cndmask_b32 v113, v113, v29, s[44:45]
    v_cndmask_b32 v114, v114, v30, s[44:45]
    v_cndmask_b32 v115, v115, v31, s[44:45]
    v_perm_b32 v112, v112, v14, s72
    v_perm_b32 v113, v113, v14, s73
    v_perm_b32 v114, v114, v14, s74
    v_perm_b32 v115, v115, v14, s75
    buffer_store_dwordx4 v[112:115], v9, s[92:95], 0 offen sc1
L_G_red:
    s_cmp_ge_u32 s5, 14
    s_cbranch_scc1 L_G_end
    s_lshl_b32 s34, s5, 3
    s_add_u32 s34, s34, s4
    s_mul_i32 s58, s34, 147
    s_lshr_b32 s58, s58, 12
    s_mul_i32 s35, s58, 28
    s_sub_u32 s59, s34, s35
    s_mul_i32 s34, s58, 896
    s_lshl_b32 s35, s59, 5
    s_add_u32 s34, s34, s35
    v_and_b32 v2, 3, v1
    v_lshlrev_b32 v2, 3, v2
    v_add_u32 v2, s34, v2
    global_load_dwordx2 v[60:61], v2, s[8:9]
    s_mov_b32 s98, 16384
L_dbg_121:
    s_load_dwordx8 s[60:67], s[28:29], 0 glc
    s_sub_u32 s98, s98, 1
    s_cbranch_scc1 L_dbgd_122
    s_waitcnt lgkmcnt(0)
    s_and_b32 s34, s60, s61
    s_and_b32 s34, s34, s62
    s_and_b32 s34, s34, s63
    s_and_b32 s34, s34, s64
    s_and_b32 s34, s34, s65
    s_and_b32 s34, s34, s66
    s_and_b32 s34, s34, s67
    s_bitcmp1_b32 s34, 0
    s_cbranch_scc1 L_dbgd_122
    s_sleep 8
    s_branch L_dbg_121
L_dbgd_122:
    s_waitcnt lgkmcnt(0)
    s_mov_b64 exec, 1
    v_mov_b32 v3, 162176
    v_mov_b32 v4, s60
    ds_write_b32 v3, v4 offset:0
    v_mov_b32 v4, s61
    ds_write_b32 v3, v4 offset:4
    v_mov_b32 v4, s62
    ds_write_b32 v3, v4 offset:8
    v_mov_b32 v4, s63
    ds_write_b32 v3, v4 offset:12
    v_mov_b32 v4, s64
    ds_write_b32 v3, v4 offset:16
    v_mov_b32 v4, s65
    ds_write_b32 v3, v4 offset:20
    v_mov_b32 v4, s66
    ds_write_b32 v3, v4 offset:24
    v_mov_b32 v4, s67
    ds_write_b32 v3, v4 offset:28
    s_mov_b64 exec, -1
    s_waitcnt lgkmcnt(0)
    v_bfe_u32 v4, v1, 2, 3
    v_lshlrev_b32 v4, 2, v4
    v_add_u32 v4, 162176, v4
    ds_read_b32 v62, v4
    v_lshlrev_b32 v4, 2, v11
    v_add_u32 v4, 162176, v4
    ds_read_b32 v63, v4
    ds_read_b32 v64, v4 offset:16
    s_mul_i32 s34, s58, 7
    s_lshr_b32 s35, s59, 2
    s_add_u32 s34, s34, s35
    s_lshl_b32 s34, s34, 13
    s_and_b32 s35, s59, 3
    s_lshl_b32 s35, s35, 6
    s_add_u32 s34, s34, s35
    v_lshrrev_b32 v3, 2, v1
    v_lshlrev_b32 v3, 8, v3
    v_and_b32 v4, 3, v1
    v_lshl_add_u32 v3, v4, 4, v3
    v_add_u32 v3, s34, v3
    v_add_u32 v5, 1441792, v3
    v_add_u32 v6, 1445888, v3
    v_add_u32 v4, 1183744, v3
    v_add_u32 v3, 1179648, v3
    s_mov_b32 s44, -1
    s_mov_b32 s45, 0xffff
    v_mov_b32 v36, 0
    v_mov_b32 v37, 0
    v_mov_b32 v38, 0
    v_mov_b32 v39, 0
    s_waitcnt lgkmcnt(0)
    s_mov_b32 s98, 262144
L_w_123:
    ds_read_b32 v40, v15 offset:56
    s_sub_u32 s98, s98, 1
    s_cbranch_scc1 L_wd_124
    s_waitcnt lgkmcnt(0)
    v_readfirstlane_b32 s99, v40
    s_cmp_ge_u32 s99, 4
    s_cbranch_scc1 L_wd_124
    s_sleep 1
    s_branch L_w_123
L_wd_124:
    s_waitcnt lgkmcnt(0)
    s_mov_b32 s98, 16384
L_dp_125:
    buffer_load_dwordx4 v[32:35], v3, s[92:95], 0 offen sc1
    s_mov_b64 exec, s[44:45]
    buffer_load_dwordx4 v[36:39], v4, s[92:95], 0 offen sc1
    s_mov_b64 exec, -1
L_dpc_127:
    s_sub_u32 s98, s98, 1
    s_cbranch_scc1 L_dpd_126
    s_waitcnt vmcnt(0)
    v_perm_b32 v40, v33, v32, s76
    v_perm_b32 v41, v35, v34, s77
    v_or_b32 v40, v40, v41
    v_cmp_eq_u32 s[40:41], v62, v40
    v_perm_b32 v40, v37, v36, s76
    v_perm_b32 v41, v39, v38, s77
    v_or_b32 v40, v40, v41
    v_cmp_eq_u32 s[42:43], v62, v40
    s_orn2_b64 s[42:43], s[42:43], s[44:45]
    s_and_b64 s[40:41], s[40:41], s[42:43]
    s_cmp_eq_u64 s[40:41], -1
    s_cbranch_scc1 L_dpd_126
    s_sleep 4
    s_branch L_dp_125
L_dpd_126:
    s_waitcnt vmcnt(0)
    v_and_b32 v32, 0xffffff00, v32
    v_and_b32 v33, 0xffffff00, v33
    v_and_b32 v34, 0xffffff00, v34
    v_and_b32 v35, 0xffffff00, v35
    v_and_b32 v36, 0xffffff00, v36
    v_and_b32 v37, 0xffffff00, v37
    v_and_b32 v38, 0xffffff00, v38
    v_and_b32 v39, 0xffffff00, v39
    v_add_f32 v32, v32, v36
    v_add_f32 v33, v33, v37
    v_add_f32 v34, v34, v38
    v_add_f32 v35, v35, v39
    v_add_f32_dpp v32, v32, v32 row_ror:4 row_mask:0xf bank_mask:0xf
    v_add_f32_dpp v33, v33, v33 row_ror:4 row_mask:0xf bank_mask:0xf
    v_add_f32_dpp v34, v34, v34 row_ror:4 row_mask:0xf bank_mask:0xf
    v_add_f32_dpp v35, v35, v35 row_ror:4 row_mask:0xf bank_mask:0xf
    v_add_f32_dpp v32, v32, v32 row_ror:8 row_mask:0xf bank_mask:0xf
    v_add_f32_dpp v33, v33, v33 row_ror:8 row_mask:0xf bank_mask:0xf
    v_add_f32_dpp v34, v34, v34 row_ror:8 row_mask:0xf bank_mask:0xf
    v_add_f32_dpp v35, v35, v35 row_ror:8 row_mask:0xf bank_mask:0xf
    v_mov_b32 v40, v32
    v_mov_b32 v41, v33
    v_mov_b32 v42, v34
    v_mov_b32 v43, v35
    v_permlane16_swap_b32 v32, v40
    v_permlane16_swap_b32 v33, v41
    v_permlane16_swap_b32 v34, v42
    v_permlane16_swap_b32 v35, v43
    v_add_f32 v32, v32, v40
    v_add_f32 v33, v33, v41
    v_add_f32 v34, v34, v42
    v_add_f32 v35, v35, v43
    v_mov_b32 v40, v32
    v_mov_b32 v41, v33
    v_mov_b32 v42, v34
    v_mov_b32 v43, v35
    v_permlane32_swap_b32 v32, v40
    v_permlane32_swap_b32 v33, v41
    v_permlane32_swap_b32 v34, v42
    v_permlane32_swap_b32 v35, v43
    v_add_f32 v32, v32, v40
    v_add_f32 v33, v33, v41
    v_add_f32 v34, v34, v42
    v_add_f32 v35, v35, v43
    v_cvt_pk_bf16_f32 v40, v32, v33
    v_lshlrev_b32 v32, 16, v40
    v_and_b32 v33, 0xffff0000, v40
    v_cvt_pk_bf16_f32 v40, v34, v35
    v_lshlrev_b32 v34, 16, v40
    v_and_b32 v35, 0xffff0000, v40
    v_mul_f32 v40, 0xbfb8aa3b, v32
    v_mul_f32 v41, 0xbfb8aa3b, v33
    v_mul_f32 v42, 0xbfb8aa3b, v34
    v_mul_f32 v43, 0xbfb8aa3b, v35
    v_exp_f32 v40, v40
    v_exp_f32 v41, v41
    v_exp_f32 v42, v42
    v_exp_f32 v43, v43
    v_add_f32 v40, 1.0, v40
    v_add_f32 v41, 1.0, v41
    v_add_f32 v42, 1.0, v42
    v_add_f32 v43, 1.0, v43
    v_rcp_f32 v40, v40
    v_rcp_f32 v41, v41
    v_rcp_f32 v42, v42
    v_rcp_f32 v43, v43
    v_mul_f32 v52, v32, v40
    v_mul_f32 v53, v33, v41
    v_mul_f32 v54, v34, v42
    v_mul_f32 v55, v35, v43
    v_cvt_pk_bf16_f32 v40, v52, v53
    v_lshlrev_b32 v52, 16, v40
    v_and_b32 v53, 0xffff0000, v40
    v_cvt_pk_bf16_f32 v40, v54, v55
    v_lshlrev_b32 v54, 16, v40
    v_and_b32 v55, 0xffff0000, v40
    v_lshlrev_b32 v56, 16, v60
    v_and_b32 v57, 0xffff0000, v60
    v_lshlrev_b32 v58, 16, v61
    v_and_b32 v59, 0xffff0000, v61
    s_mov_b32 s48, s26
    s_mov_b32 s49, s27
    s_mov_b32 s50, 3584
    s_mov_b32 s51, 0x20000
    s_mov_b32 s98, 262144
L_w_128:
    ds_read_b32 v16, v15 offset:60
    s_sub_u32 s98, s98, 1
    s_cbranch_scc1 L_wd_129
    s_waitcnt lgkmcnt(0)
    v_readfirstlane_b32 s99, v16
    s_cmp_ge_u32 s99, 4
    s_cbranch_scc0 L_w_128
L_wd_129:
    s_waitcnt lgkmcnt(0)
    s_mov_b32 s98, 16384
L_yg_130:
    buffer_load_dwordx4 v[16:19], v5, s[92:95], 0 offen sc1
    buffer_load_dwordx4 v[20:23], v6, s[92:95], 0 offen sc1
L_ygc_132:
    s_sub_u32 s98, s98, 1
    s_cbranch_scc1 L_ygd_131
    s_waitcnt vmcnt(0)
    v_perm_b32 v40, v17, v16, s76
    v_perm_b32 v41, v19, v18, s77
    v_or_b32 v40, v40, v41
    v_cmp_eq_u32 s[40:41], v63, v40
    v_perm_b32 v40, v21, v20, s76
    v_perm_b32 v41, v23, v22, s77
    v_or_b32 v40, v40, v41
    v_cmp_eq_u32 s[42:43], v64, v40
    s_and_b64 s[40:41], s[40:41], s[42:43]
    s_cmp_eq_u64 s[40:41], -1
    s_cbranch_scc1 L_ygd_131
    s_branch L_yg_130
L_ygd_131:
    s_waitcnt vmcnt(0)
    v_and_b32 v16, 0xffffff00, v16
    v_and_b32 v17, 0xffffff00, v17
    v_and_b32 v18, 0xffffff00, v18
    v_and_b32 v19, 0xffffff00, v19
    v_and_b32 v20, 0xffffff00, v20
    v_and_b32 v21, 0xffffff00, v21
    v_and_b32 v22, 0xffffff00, v22
    v_and_b32 v23, 0xffffff00, v23
    v_add_f32 v16, v16, v20
    v_add_f32 v17, v17, v21
    v_add_f32 v18, v18, v22
    v_add_f32 v19, v19, v23
    v_add_f32_dpp v16, v16, v16 row_ror:4 row_mask:0xf bank_mask:0xf
    v_add_f32_dpp v17, v17, v17 row_ror:4 row_mask:0xf bank_mask:0xf
    v_add_f32_dpp v18, v18, v18 row_ror:4 row_mask:0xf bank_mask:0xf
    v_add_f32_dpp v19, v19, v19 row_ror:4 row_mask:0xf bank_mask:0xf
    v_add_f32_dpp v16, v16, v16 row_ror:8 row_mask:0xf bank_mask:0xf
    v_add_f32_dpp v17, v17, v17 row_ror:8 row_mask:0xf bank_mask:0xf
    v_add_f32_dpp v18, v18, v18 row_ror:8 row_mask:0xf bank_mask:0xf
    v_add_f32_dpp v19, v19, v19 row_ror:8 row_mask:0xf bank_mask:0xf
    v_mov_b32 v40, v16
    v_mov_b32 v41, v17
    v_mov_b32 v42, v18
    v_mov_b32 v43, v19
    v_permlane16_swap_b32 v16, v40
    v_permlane16_swap_b32 v17, v41
    v_permlane16_swap_b32 v18, v42
    v_permlane16_swap_b32 v19, v43
    v_add_f32 v16, v16, v40
    v_add_f32 v17, v17, v41
    v_add_f32 v18, v18, v42
    v_add_f32 v19, v19, v43
    v_mov_b32 v40, v16
    v_mov_b32 v41, v17
    v_mov_b32 v42, v18
    v_mov_b32 v43, v19
    v_permlane32_swap_b32 v16, v40
    v_permlane32_swap_b32 v17, v41
    v_permlane32_swap_b32 v18, v42
    v_permlane32_swap_b32 v19, v43
    v_add_f32 v16, v16, v40
    v_add_f32 v17, v17, v41
    v_add_f32 v18, v18, v42
    v_add_f32 v19, v19, v43
    v_cvt_pk_bf16_f32 v40, v16, v17
    v_lshlrev_b32 v16, 16, v40
    v_and_b32 v17, 0xffff0000, v40
    v_cvt_pk_bf16_f32 v40, v18, v19
    v_lshlrev_b32 v18, 16, v40
    v_and_b32 v19, 0xffff0000, v40
    v_mul_f32 v16, v16, v52
    v_mul_f32 v17, v17, v53
    v_mul_f32 v18, v18, v54
    v_mul_f32 v19, v19, v55
    v_cvt_pk_bf16_f32 v40, v16, v17
    v_lshlrev_b32 v16, 16, v40
    v_and_b32 v17, 0xffff0000, v40
    v_cvt_pk_bf16_f32 v40, v18, v19
    v_lshlrev_b32 v18, 16, v40
    v_and_b32 v19, 0xffff0000, v40
    v_add_f32 v16, v16, v56
    v_add_f32 v17, v17, v57
    v_add_f32 v18, v18, v58
    v_add_f32 v19, v19, v59
    v_cvt_pk_bf16_f32 v20, v16, v17
    v_cvt_pk_bf16_f32 v21, v18, v19
    s_mov_b64 exec, 0xf
    buffer_store_dwordx2 v[20:21], v2, s[48:51], 0 offen
    s_mov_b64 exec, -1
L_G_end:
    s_waitcnt vmcnt(0) lgkmcnt(0)
    s_endpgm
L_END:
    s_endpgm
.section .rodata,"a"
.p2align 6
.amdhsa_kernel recurrent_scan__sliding_block_cached__glu_gated_reglu__decode_kernel
  .amdhsa_next_free_vgpr 256
  .amdhsa_next_free_sgpr 102
  .amdhsa_accum_offset 256
  .amdhsa_group_segment_fixed_size 0
  .amdhsa_kernarg_size 96
  .amdhsa_user_sgpr_count 2
  .amdhsa_user_sgpr_kernarg_segment_ptr 1
  .amdhsa_system_sgpr_workgroup_id_x 1
.end_amdhsa_kernel
```
